```python
import torch

def _softmax(x, axis=-1):
    return torch.softmax(x, dim=axis)
def _gelu(x):
    return torch.nn.functional.gelu(x, approximate="tanh")
def _silu(x):
    return torch.nn.functional.silu(x)
def _sigmoid(x):
    return torch.sigmoid(x)
def _layernorm(x, axis=-1, eps=1e-5):
    m = x.mean(dim=axis, keepdim=True)
    v = x.var(dim=axis, keepdim=True, unbiased=False)
    return (x - m) / torch.sqrt(v + eps)
def _scatter_add(tgt, idx, src, axis=0):
    return tgt.clone().index_add_(axis, idx, src)
def _segment_sum(src, seg, n):
    out = torch.zeros((n,) + src.shape[1:], dtype=src.dtype)
    return out.index_add_(0, seg, src)
def _pad(x, pw):
    flat = tuple(v for pair in reversed(pw) for v in pair)
    return torch.nn.functional.pad(x, flat)

kernel_name = 'gated_mix__linear_kernel_hedgehog__ssm_conv_s4d__prompt'

def setup_inputs():

    _w = (lambda a: (lambda t: t.to(torch.bfloat16) if t.is_floating_point() else t)(torch.as_tensor(a)))
    def _A_setup():
        B, S, D, H = 1, 2048, 512, 32
        Dh = D // H
        return {
            "x": _w((lambda *s: torch.randn(*s, dtype=torch.bfloat16) * 0.05)(B, S, D)),
            "wqkv": _w((lambda *s: torch.randn(*s, dtype=torch.bfloat16) * 0.8)(D, 3 * D)),
            "w_phi": _w((lambda *s: torch.randn(*s, dtype=torch.bfloat16) * 0.8)(H, Dh, Dh) * (Dh ** -0.5)),
            "wo": _w((lambda *s: torch.randn(*s, dtype=torch.bfloat16) * 0.05)(D, D)),
        }
    _A_in = _A_setup()

    def _B_setup():
        Bsz, L, D, N = 1, 2048, 512, 128
        return {
            "u": _w((lambda *s: torch.randn(*s, dtype=torch.bfloat16) * 0.05)(Bsz, L, D)),
            "log_A_real": _w((lambda *s: torch.randn(*s, dtype=torch.bfloat16) * 6.4)(D, N) * 0.5),
            "A_imag": _w((lambda *s: torch.randn(*s, dtype=torch.bfloat16) * 0.05)(D, N) * 3.14),
            "C_real": _w((lambda *s: torch.randn(*s, dtype=torch.bfloat16) * 0.2)(D, N) / N ** 0.5),
            "C_imag": _w((lambda *s: torch.randn(*s, dtype=torch.bfloat16) * 0.2)(D, N) / N ** 0.5),
            "log_dt": _w((lambda *s: torch.randn(*s, dtype=torch.bfloat16) * 0.05)(D) * 0.5 - 4.0),
            "D_skip": _w((lambda *s: torch.randn(*s, dtype=torch.bfloat16) * 0.05)(D)),
        }
    _B_in = _B_setup()

    return {
        "A_x": _A_in["x"],
        "A_wqkv": _A_in["wqkv"],
        "A_w_phi": _A_in["w_phi"],
        "A_wo": _A_in["wo"],
        "B_u": _B_in["u"],
        "B_log_A_real": _B_in["log_A_real"],
        "B_A_imag": _B_in["A_imag"],
        "B_C_real": _B_in["C_real"],
        "B_C_imag": _B_in["C_imag"],
        "B_log_dt": _B_in["log_dt"],
        "B_D_skip": _B_in["D_skip"],
        "gate_w": _w((lambda *s: torch.randn(*s, dtype=torch.bfloat16) * 0.05)(512) * 16.0),
    }

def reference(A_x, A_wqkv, A_w_phi, A_wo, B_u, B_log_A_real, B_A_imag, B_C_real, B_C_imag, B_log_dt, B_D_skip, gate_w):
    def _A_ref(x, wqkv, w_phi, wo):
        B, S, D = x.shape
        H = 32; Dh = D // H
        qkv = (lambda x, *d: x.permute(*d))((x @ wqkv).reshape(B, S, 3, H, Dh), 2, 0, 3, 1, 4)
        q, k, v = qkv[0], qkv[1], qkv[2]
        pq = torch.einsum("bhsd,hdf->bhsf", q, w_phi)
        pk = torch.einsum("bhsd,hdf->bhsf", k, w_phi)
        phi_q = torch.concatenate([_softmax(pq, axis=-1), _softmax(-pq, axis=-1)], axis=-1)
        phi_k = torch.concatenate([_softmax(pk, axis=-1), _softmax(-pk, axis=-1)], axis=-1)
        kv = torch.einsum("bhsf,bhsd->bhfd", phi_k, v)
        z  = torch.einsum("bhsf->bhf", phi_k)
        num = torch.einsum("bhqf,bhfd->bhqd", phi_q, kv)
        den = torch.einsum("bhqf,bhf->bhq", phi_q, z)[..., None] + 1e-6
        o = num / den
        return (lambda x, *d: x.permute(*d))(o, 0, 2, 1, 3).reshape(B, S, D) @ wo

    def _B_ref(u, log_A_real, A_imag, C_real, C_imag, log_dt, D_skip):
        L = u.shape[1]
        dt = torch.exp(log_dt)
        A = -torch.exp(log_A_real) + 1j * A_imag
        C = (C_real + 1j * C_imag) * dt[:, None]
        pos = (lambda x, dt: x.to(dt))(torch.arange(L), log_dt.dtype)
        P = torch.exp((A * dt[:, None])[:, :, None] * pos[None, None, :])
        K = 2.0 * torch.einsum("dn,dnl->dl", C, P).real
        L2 = 2 * L
        u_t = (lambda x, *d: x.permute(*d))(u, 0, 2, 1)
        Kf = (lambda x, *a, **k: torch.fft.rfft(x.float(), *a, **k))(K, L2)
        Uf = (lambda x, *a, **k: torch.fft.rfft(x.float(), *a, **k))(u_t, L2)
        y = (lambda x, *a, **k: torch.fft.irfft(x, *a, **k).to(torch.bfloat16))(Uf * Kf[None, :, :], L2)[:, :, :L]
        y = (lambda x, *d: x.permute(*d))(y, 0, 2, 1)
        return y + u * D_skip[None, None, :]

    x = A_x
    g = _sigmoid((x * gate_w).sum(-1, keepdims=True))
    a = _A_ref(x, A_wqkv, A_w_phi, A_wo)
    b = _B_ref(x, B_log_A_real, B_A_imag, B_C_real, B_C_imag, B_log_dt, B_D_skip)
    return g * a + (1 - g) * b
```

```asm
; @launch grid=(256,1,1) block=(256,1,1) lds=163840
.amdgcn_target "amdgcn-amd-amdhsa--gfx950"
.text
.globl gated_mix__linear_kernel_hedgehog__ssm_conv_s4d__prompt_kernel
.p2align 8
.type gated_mix__linear_kernel_hedgehog__ssm_conv_s4d__prompt_kernel,@function
gated_mix__linear_kernel_hedgehog__ssm_conv_s4d__prompt_kernel:
    s_cmp_ge_u32 s2, 256
    s_cbranch_scc1 L1_exit
L1_begin:
    s_getpc_b64 s[30:31]
    v_lshlrev_b32 v1, 7, v0
    v_min_u32 v1, L2c_gtab_end-L1_begin-64, v1
    global_load_dword v1, v1, s[30:31]
    s_load_dwordx16 s[4:19], s[0:1], 0
    s_load_dwordx8 s[20:27], s[0:1], 64
    s_load_dwordx2 s[28:29], s[0:1], 112
    s_load_dwordx4 s[76:79], s[0:1], 96
    v_and_b32 v2, 63, v0
    v_lshrrev_b32 v4, 6, v0
    s_and_b32 s30, s2, 7
    v_readfirstlane_b32 s62, v4
    s_lshr_b32 s31, s2, 3
    s_lshr_b32 s60, s30, 1
    s_lshl_b32 s60, s60, 3
    s_and_b32 s61, s31, 7
    s_add_u32 s60, s60, s61
    s_and_b32 s61, s30, 1
    s_lshl_b32 s61, s61, 2
    s_lshr_b32 s31, s31, 3
    s_add_u32 s61, s61, s31
    s_and_b32 s63, s62, 1
    s_lshr_b32 s64, s62, 1
    s_lshl_b32 s65, s2, 1
    s_add_u32 s65, s65, s64
    s_lshl_b32 s30, s65, 8
    s_lshl_b32 s31, s63, 7
    s_add_u32 s30, s30, s31
    v_lshlrev_b32 v4, 1, v2
    v_add_u32 v10, s30, v4
    s_lshl_b32 s30, s65, 1
    v_mov_b32 v11, s30
    s_add_u32 s69, s60, s61
    s_and_b32 s69, s69, 7
    s_lshl_b32 s66, s69, 7
    s_add_u32 s66, s66, 960
    s_mul_i32 s70, s62, 4608
    s_add_u32 s70, s70, 98304
    v_lshrrev_b32 v4, 2, v2
    v_and_b32 v4, 4, v4
    v_xor_b32 v4, v4, v2
    v_and_b32 v4, 7, v4
    v_lshlrev_b32 v4, 4, v4
    v_lshrrev_b32 v5, 3, v2
    s_lshl_b32 s30, s62, 3
    v_add_u32 v5, s30, v5
    v_mul_u32_u24 v5, 3072, v5
    s_lshl_b32 s30, s61, 7
    v_add3_u32 v9, v5, v4, s30
    v_lshrrev_b32 v4, 4, v2
    v_xor_b32 v4, v4, v2
    v_and_b32 v4, 3, v4
    v_lshlrev_b32 v4, 4, v4
    s_lshl_b32 s30, s69, 7
    v_add_u32 v12, s30, v4
    v_lshrrev_b32 v5, 2, v2
    s_lshl_b32 s30, s60, 6
    s_lshl_b32 s31, s62, 4
    s_add_u32 s30, s30, s31
    v_add_u32 v5, s30, v5
    v_lshl_add_u32 v8, v5, 10, v4
    s_lshl_b32 s68, s62, 12
    s_waitcnt lgkmcnt(0)
    s_mov_b32 s44, s28
    s_and_b32 s45, s29, 0xffff
    s_mov_b32 s46, 15073280
    s_mov_b32 s47, 0x20000
    s_mov_b32 s80, s78
    s_and_b32 s81, s79, 0xffff
    s_mov_b32 s82, 256
    s_mov_b32 s83, 0x20000
    s_lshl_b32 s30, s69, 5
    s_add_u32 s30, s30, s60
    s_lshl_b32 s84, s30, 7
    s_add_u32 s84, s84, 14942208
    s_lshl_b32 s30, s61, 5
    s_add_u32 s30, s30, s60
    s_lshl_b32 s85, s30, 7
    s_add_u32 s85, s85, 14974976
    s_lshl_b32 s30, s2, 7
    s_add_u32 s86, s30, 15007744
    s_add_u32 s87, s30, 15040512
    s_and_b32 s30, s2, 7
    s_lshr_b32 s31, s2, 3
    s_lshl_b32 s88, s30, 2
    s_and_b32 s89, s31, 3
    s_add_u32 s88, s88, s89
    s_lshr_b32 s89, s31, 2
    s_mov_b32 s48, s22
    s_and_b32 s49, s23, 0xffff
    s_mov_b32 s50, 1024
    s_mov_b32 s51, 0x20000
    buffer_load_ushort v18, v11, s[48:51], 0 offen
    s_mov_b32 s52, s14
    s_and_b32 s53, s15, 0xffff
    s_mov_b32 s54, 131072
    s_mov_b32 s55, 0x20000
    buffer_load_ushort v14, v10, s[52:55], 0 offen
    s_mov_b32 s48, s16
    s_and_b32 s49, s17, 0xffff
    s_mov_b32 s50, 131072
    s_mov_b32 s51, 0x20000
    buffer_load_ushort v15, v10, s[48:51], 0 offen
    s_mov_b32 s52, s18
    s_and_b32 s53, s19, 0xffff
    s_mov_b32 s54, 131072
    s_mov_b32 s55, 0x20000
    buffer_load_ushort v16, v10, s[52:55], 0 offen
    s_mov_b32 s48, s20
    s_and_b32 s49, s21, 0xffff
    s_mov_b32 s50, 131072
    s_mov_b32 s51, 0x20000
    buffer_load_ushort v17, v10, s[48:51], 0 offen
    s_mov_b32 s52, s24
    s_and_b32 s53, s25, 0xffff
    s_mov_b32 s54, 1024
    s_mov_b32 s55, 0x20000
    buffer_load_ushort v19, v11, s[52:55], 0 offen
    s_mov_b32 s36, s6
    s_and_b32 s37, s7, 0xffff
    s_mov_b32 s38, 1572864
    s_mov_b32 s39, 0x20000
    s_sub_u32 s32, s4, 3072
    s_subb_u32 s33, s5, 0
    s_and_b32 s33, s33, 0xffff
    s_mov_b32 s34, 2100224
    s_mov_b32 s35, 0x20000
    s_add_u32 s66, s66, 64
    s_and_b32 s66, s66, 1023
    s_add_u32 m0, s68, 0
    s_mul_i32 s67, s66, 1536
    buffer_load_dwordx4 v8, s[32:35], s66 offen offset:3072 lds
    buffer_load_dwordx4 v9, s[36:39], s67 offen offset:0 lds
    buffer_load_dwordx4 v9, s[36:39], s67 offen offset:1024 lds
    buffer_load_dwordx4 v9, s[36:39], s67 offen offset:2048 lds
    s_mov_b32 s56, s26
    s_and_b32 s57, s27, 0xffff
    s_mov_b32 s58, 1024
    s_mov_b32 s59, 0x20000
    s_mov_b32 s40, s8
    s_and_b32 s41, s9, 0xffff
    s_mov_b32 s42, 16384
    s_mov_b32 s43, 0x20000
    s_lshl_b32 s30, s61, 11
    s_lshl_b32 s31, s64, 10
    s_add_u32 s30, s30, s31
    v_lshlrev_b32 v4, 4, v2
    v_add_u32 v13, s30, v4
    v_lshrrev_b32 v30, 4, v2
    v_and_b32 v31, 15, v2
    v_and_b32 v34, 31, v2
    v_lshrrev_b32 v33, 5, v2
    v_mul_u32_u24 v4, 288, v31
    v_lshl_add_u32 v4, v30, 4, v4
    v_add_u32 v32, s70, v4
    v_bfe_u32 v4, v2, 2, 2
    v_bfe_u32 v5, v2, 4, 1
    v_lshl_add_u32 v4, v5, 3, v4
    v_lshlrev_b32 v4, 6, v4
    v_lshl_add_u32 v4, v33, 12, v4
    v_and_b32 v6, 1, v2
    v_lshl_add_u32 v4, v6, 3, v4
    v_bfe_u32 v6, v2, 1, 1
    s_lshl_b32 s30, s63, 1
    v_add_u32 v6, s30, v6
    v_lshlrev_b32 v5, 1, v5
    v_xor_b32 v6, v6, v5
    v_lshl_add_u32 v4, v6, 4, v4
    s_lshl_b32 s30, s64, 14
    s_add_u32 s30, s30, 3072
    v_add_u32 v35, s30, v4
    v_xor_b32 v36, 16, v35
    v_add_u32 v36, 256, v36
    s_lshl_b32 s30, s62, 11
    s_add_u32 s30, s30, 116736
    v_and_b32 v4, 7, v31
    v_xor_b32 v4, v4, v30
    v_lshlrev_b32 v4, 4, v4
    v_lshl_add_u32 v4, v31, 7, v4
    v_add_u32 v37, s30, v4
    v_lshrrev_b32 v4, 3, v2
    v_xor_b32 v5, v4, v2
    v_and_b32 v5, 7, v5
    v_lshlrev_b32 v5, 4, v5
    v_lshl_add_u32 v5, v4, 7, v5
    v_add_u32 v38, s30, v5
    s_lshl_b32 s30, s69, 6
    s_lshl_b32 s31, s62, 4
    s_add_u32 s30, s30, s31
    v_add_u32 v4, s30, v4
    v_lshlrev_b32 v4, 12, v4
    v_and_b32 v5, 7, v2
    v_lshl_add_u32 v4, v5, 4, v4
    s_lshl_b32 s30, s60, 7
    s_add_u32 s30, s30, 0
    v_add_u32 v39, s30, v4
    v_lshlrev_b32 v4, 4, v2
    s_add_u32 s30, s68, 3072
    v_add_u32 v40, s30, v4
    v_add_u32 v41, s70, v4
    s_xor_b32 s30, s62, 1
    s_mul_i32 s31, s30, 4608
    s_add_u32 s31, s31, 98304
    v_add_u32 v42, s31, v4
    s_lshl_b32 s30, s30, 12
    v_add_u32 v58, s30, v4
    v_add_u32 v59, s68, v4
    s_mul_i32 s30, s64, 3200
    s_add_u32 s30, s30, 129536
    v_add_u32 v43, s30, v4
    s_lshl_b32 s30, s69, 11
    s_lshl_b32 s31, s60, 6
    s_add_u32 s30, s30, s31
    s_lshl_b32 s31, s62, 4
    s_add_u32 s30, s30, s31
    v_lshrrev_b32 v4, 2, v2
    v_add_u32 v4, s30, v4
    v_lshlrev_b32 v4, 2, v4
    v_add_u32 v44, 4259840, v4
    v_lshrrev_b32 v4, 2, v34
    v_and_b32 v4, 3, v4
    v_xor_b32 v4, v4, v33
    v_lshlrev_b32 v4, 4, v4
    v_lshl_add_u32 v4, v31, 6, v4
    v_bfe_u32 v5, v2, 4, 1
    v_lshl_add_u32 v4, v5, 12, v4
    s_lshl_b32 s30, s63, 13
    s_add_u32 s30, s30, 3072
    v_add_u32 v45, s30, v4
    v_xor_b32 v46, 32, v45
    v_bfe_u32 v4, v2, 2, 2
    v_lshlrev_b32 v5, 7, v4
    v_lshl_add_u32 v5, v33, 12, v5
    v_lshrrev_b32 v4, 1, v4
    v_xor_b32 v4, s64, v4
    v_lshl_add_u32 v5, v4, 6, v5
    v_bfe_u32 v6, v2, 4, 1
    v_and_b32 v7, 3, v2
    v_lshlrev_b32 v4, 5, v6
    v_lshl_add_u32 v4, v7, 3, v4
    v_add_u32 v48, v5, v4
    v_and_b32 v4, 1, v7
    v_lshlrev_b32 v4, 5, v4
    v_lshl_add_u32 v4, v6, 4, v4
    v_lshrrev_b32 v7, 1, v7
    v_lshl_add_u32 v4, v7, 3, v4
    v_add_u32 v47, v5, v4
    v_add_u32 v49, 0x10000, v45
    v_add_u32 v50, 0x10000, v46
    v_add_u32 v51, 0x10000, v47
    v_add_u32 v52, 0x10000, v48
    v_mov_b32 v66, 0
    v_mov_b32 v67, 0
    v_lshlrev_b32 v4, 3, v2
    v_add_u32 v4, 129024, v4
    ds_write_b64 v4, v[66:67]
    s_mov_b32 s72, 0x3fb8aa3b
    s_mov_b32 s73, 0x3fb8aa3b
    s_lshl_b32 s30, s60, 16
    s_lshl_b32 s31, s61, 13
    s_add_u32 s30, s30, s31
    s_lshl_b32 s31, s64, 12
    s_add_u32 s30, s30, s31
    s_lshl_b32 s31, s63, 9
    s_add_u32 s30, s30, s31
    s_add_u32 s30, s30, 6553600
    v_lshlrev_b32 v4, 11, v33
    v_lshl_add_u32 v4, v34, 4, v4
    v_add_u32 v57, s30, v4
    v_bfe_u32 v4, v34, 1, 2
    v_lshlrev_b32 v4, 4, v4
    v_lshl_add_u32 v4, v34, 6, v4
    v_lshl_add_u32 v4, v33, 11, v4
    v_add_u32 v54, s68, v4
    v_bfe_u32 v4, v2, 2, 2
    v_lshl_add_u32 v5, v33, 2, v4
    v_lshlrev_b32 v5, 6, v5
    v_lshrrev_b32 v4, 1, v4
    v_lshl_add_u32 v4, v33, 1, v4
    v_bfe_u32 v6, v2, 4, 1
    v_and_b32 v7, 1, v2
    v_lshl_add_u32 v6, v6, 1, v7
    v_xor_b32 v4, v4, v6
    v_lshl_add_u32 v5, v4, 4, v5
    v_bfe_u32 v4, v2, 1, 1
    v_lshl_add_u32 v5, v4, 3, v5
    s_lshl_b32 s31, s63, 11
    s_add_u32 s30, s68, s31
    v_add_u32 v55, s30, v5
    v_xor_b32 v56, 2048, v55
    v_bfe_u32 v4, v2, 4, 1
    v_cmp_eq_u32 s[74:75], s63, v4
    s_lshl_b32 s30, s61, 2
    s_lshl_b32 s31, s64, 1
    s_add_u32 s30, s30, s31
    s_add_u32 s30, s30, s63
    s_mul_i32 s30, s30, 34816
    s_mul_i32 s31, s60, 1088
    s_add_u32 s30, s30, s31
    s_add_u32 s30, s30, 4325376
    s_lshl_b32 s31, s63, 4
    v_xor_b32 v64, s31, v34
    v_lshlrev_b32 v4, 4, v64
    v_lshl_add_u32 v4, v33, 8, v4
    v_lshlrev_b32 v5, 4, v33
    v_add_u32 v5, 1024, v5
    v_cmp_gt_u32 vcc, 16, v64
    s_nop 1
    v_cndmask_b32 v4, v5, v4, vcc
    v_add_u32 v60, s30, v4
    v_mov_b32 v4, 32
    v_mov_b32 v5, 512
    v_cndmask_b32 v4, v4, v5, vcc
    v_add_u32 v61, v60, v4
    s_lshl_b32 s30, s62, 10
    s_add_u32 s30, s30, 124928
    v_bfe_u32 v4, v2, 2, 2
    v_lshlrev_b32 v4, 5, v4
    v_bfe_u32 v5, v2, 4, 1
    v_lshl_add_u32 v4, v5, 4, v4
    v_bfe_u32 v5, v2, 1, 1
    v_lshl_add_u32 v4, v5, 3, v4
    v_lshl_add_u32 v4, v33, 9, v4
    v_add_u32 v4, s30, v4
    v_and_b32 v5, 1, v2
    v_cmp_eq_u32 vcc, v5, v33
    v_mov_b32 v6, 129024
    s_nop 0
    v_cndmask_b32 v53, v6, v4, vcc
    s_waitcnt vmcnt(4)
    s_or_b32 s30, s2, s62
    s_cmp_eq_u32 s30, 0
    s_cbranch_scc0 LF_notag
    s_memrealtime s[94:95]
    s_waitcnt lgkmcnt(0)
    s_or_b32 s94, s94, 1
    s_mov_b64 exec, 1
    v_mov_b32 v28, 0
    v_mov_b32 v29, s94
    buffer_store_dword v29, v28, s[80:83], 0 offen sc1
    s_mov_b64 exec, -1
LF_notag:
    v_lshlrev_b32 v18, 16, v18
    v_lshlrev_b32 v14, 16, v14
    v_mul_f32 v18, 0x3fb8aa3b, v18
    v_mul_f32 v14, 0x3fb8aa3b, v14
    v_exp_f32 v18, v18
    v_exp_f32 v14, v14
    v_lshlrev_b32 v15, 16, v15
    v_cvt_pk_bf16_f32 v4, v18, v14
    v_lshlrev_b32 v68, 16, v4
    v_and_b32 v14, 0xffff0000, v4
    v_mul_f32 v69, v14, v68
    v_mul_f32 v70, v15, v68
    v_lshlrev_b32 v16, 16, v16
    v_lshlrev_b32 v17, 16, v17
    v_add_f32 v4, v68, v68
    v_mul_f32 v78, v16, v4
    v_mul_f32 v79, v17, v4
    v_mul_f32 v69, 0xbfb8aa3b, v69
    v_mul_f32 v70, 0x3e22f983, v70
    s_mov_b32 m0, s70
    v_mul_f32 v4, 0x41000000, v69
    v_mul_f32 v5, 0x41000000, v70
    v_exp_f32 v4, v4
    v_fract_f32 v5, v5
    v_cos_f32 v74, v5
    v_sin_f32 v75, v5
    s_nop 0
    v_pk_mul_f32 v[74:75], v[74:75], v[4:5] op_sel_hi:[1,0]
    v_mul_f32 v4, 0x3f800000, v69
    v_mul_f32 v5, 0x3f800000, v70
    v_exp_f32 v4, v4
    v_fract_f32 v5, v5
    v_cos_f32 v72, v5
    v_sin_f32 v73, v5
    s_nop 0
    v_pk_mul_f32 v[72:73], v[72:73], v[4:5] op_sel_hi:[1,0]
    v_mul_f32 v4, 0x43000000, v69
    v_mul_f32 v5, 0x43000000, v70
    v_exp_f32 v4, v4
    v_fract_f32 v5, v5
    v_cos_f32 v76, v5
    v_sin_f32 v77, v5
    s_nop 0
    v_pk_mul_f32 v[76:77], v[76:77], v[4:5] op_sel_hi:[1,0]
    v_cvt_pk_bf16_f32 v82, v78, -v79
    ds_write_addtid_b32 v82 offset:0
    v_pk_mul_f32 v[80:81], v[78:79], v[74:75] op_sel:[0,0] op_sel_hi:[0,1]
    v_pk_fma_f32 v[84:85], v[78:79], v[74:75], v[80:81] op_sel:[1,1,0] op_sel_hi:[1,0,1] neg_lo:[1,0,0]
    v_cvt_pk_bf16_f32 v83, v84, -v85
    ds_write_addtid_b32 v83 offset:288
    v_pk_mul_f32 v[80:81], v[84:85], v[74:75] op_sel:[0,0] op_sel_hi:[0,1]
    v_pk_fma_f32 v[84:85], v[84:85], v[74:75], v[80:81] op_sel:[1,1,0] op_sel_hi:[1,0,1] neg_lo:[1,0,0]
    v_cvt_pk_bf16_f32 v82, v84, -v85
    ds_write_addtid_b32 v82 offset:576
    v_pk_mul_f32 v[80:81], v[84:85], v[74:75] op_sel:[0,0] op_sel_hi:[0,1]
    v_pk_fma_f32 v[84:85], v[84:85], v[74:75], v[80:81] op_sel:[1,1,0] op_sel_hi:[1,0,1] neg_lo:[1,0,0]
    v_cvt_pk_bf16_f32 v83, v84, -v85
    ds_write_addtid_b32 v83 offset:864
    v_pk_mul_f32 v[80:81], v[84:85], v[74:75] op_sel:[0,0] op_sel_hi:[0,1]
    v_pk_fma_f32 v[84:85], v[84:85], v[74:75], v[80:81] op_sel:[1,1,0] op_sel_hi:[1,0,1] neg_lo:[1,0,0]
    v_cvt_pk_bf16_f32 v82, v84, -v85
    ds_write_addtid_b32 v82 offset:1152
    v_pk_mul_f32 v[80:81], v[84:85], v[74:75] op_sel:[0,0] op_sel_hi:[0,1]
    v_pk_fma_f32 v[84:85], v[84:85], v[74:75], v[80:81] op_sel:[1,1,0] op_sel_hi:[1,0,1] neg_lo:[1,0,0]
    v_cvt_pk_bf16_f32 v83, v84, -v85
    ds_write_addtid_b32 v83 offset:1440
    s_add_u32 s66, s66, 64
    s_and_b32 s66, s66, 1023
    s_add_u32 m0, s68, 16384
    s_mul_i32 s67, s66, 1536
    buffer_load_dwordx4 v8, s[32:35], s66 offen offset:3072 lds
    s_mov_b32 m0, s70
    v_pk_mul_f32 v[80:81], v[84:85], v[74:75] op_sel:[0,0] op_sel_hi:[0,1]
    v_pk_fma_f32 v[84:85], v[84:85], v[74:75], v[80:81] op_sel:[1,1,0] op_sel_hi:[1,0,1] neg_lo:[1,0,0]
    v_cvt_pk_bf16_f32 v82, v84, -v85
    ds_write_addtid_b32 v82 offset:1728
    v_pk_mul_f32 v[80:81], v[84:85], v[74:75] op_sel:[0,0] op_sel_hi:[0,1]
    v_pk_fma_f32 v[84:85], v[84:85], v[74:75], v[80:81] op_sel:[1,1,0] op_sel_hi:[1,0,1] neg_lo:[1,0,0]
    v_cvt_pk_bf16_f32 v83, v84, -v85
    ds_write_addtid_b32 v83 offset:2016
    v_pk_mul_f32 v[80:81], v[84:85], v[74:75] op_sel:[0,0] op_sel_hi:[0,1]
    v_pk_fma_f32 v[84:85], v[84:85], v[74:75], v[80:81] op_sel:[1,1,0] op_sel_hi:[1,0,1] neg_lo:[1,0,0]
    v_cvt_pk_bf16_f32 v82, v84, -v85
    ds_write_addtid_b32 v82 offset:2304
    v_pk_mul_f32 v[80:81], v[84:85], v[74:75] op_sel:[0,0] op_sel_hi:[0,1]
    v_pk_fma_f32 v[84:85], v[84:85], v[74:75], v[80:81] op_sel:[1,1,0] op_sel_hi:[1,0,1] neg_lo:[1,0,0]
    v_cvt_pk_bf16_f32 v83, v84, -v85
    ds_write_addtid_b32 v83 offset:2592
    v_pk_mul_f32 v[80:81], v[84:85], v[74:75] op_sel:[0,0] op_sel_hi:[0,1]
    v_pk_fma_f32 v[84:85], v[84:85], v[74:75], v[80:81] op_sel:[1,1,0] op_sel_hi:[1,0,1] neg_lo:[1,0,0]
    v_cvt_pk_bf16_f32 v82, v84, -v85
    ds_write_addtid_b32 v82 offset:2880
    v_pk_mul_f32 v[80:81], v[84:85], v[74:75] op_sel:[0,0] op_sel_hi:[0,1]
    v_pk_fma_f32 v[84:85], v[84:85], v[74:75], v[80:81] op_sel:[1,1,0] op_sel_hi:[1,0,1] neg_lo:[1,0,0]
    v_cvt_pk_bf16_f32 v83, v84, -v85
    ds_write_addtid_b32 v83 offset:3168
    s_add_u32 m0, s68, 16384
    s_nop 0
    buffer_load_dwordx4 v9, s[36:39], s67 offen offset:0 lds
    s_mov_b32 m0, s70
    v_pk_mul_f32 v[80:81], v[84:85], v[74:75] op_sel:[0,0] op_sel_hi:[0,1]
    v_pk_fma_f32 v[84:85], v[84:85], v[74:75], v[80:81] op_sel:[1,1,0] op_sel_hi:[1,0,1] neg_lo:[1,0,0]
    v_cvt_pk_bf16_f32 v82, v84, -v85
    ds_write_addtid_b32 v82 offset:3456
    v_pk_mul_f32 v[80:81], v[84:85], v[74:75] op_sel:[0,0] op_sel_hi:[0,1]
    v_pk_fma_f32 v[84:85], v[84:85], v[74:75], v[80:81] op_sel:[1,1,0] op_sel_hi:[1,0,1] neg_lo:[1,0,0]
    v_cvt_pk_bf16_f32 v83, v84, -v85
    ds_write_addtid_b32 v83 offset:3744
    v_pk_mul_f32 v[80:81], v[84:85], v[74:75] op_sel:[0,0] op_sel_hi:[0,1]
    v_pk_fma_f32 v[84:85], v[84:85], v[74:75], v[80:81] op_sel:[1,1,0] op_sel_hi:[1,0,1] neg_lo:[1,0,0]
    v_cvt_pk_bf16_f32 v82, v84, -v85
    ds_write_addtid_b32 v82 offset:4032
    v_pk_mul_f32 v[80:81], v[84:85], v[74:75] op_sel:[0,0] op_sel_hi:[0,1]
    v_pk_fma_f32 v[84:85], v[84:85], v[74:75], v[80:81] op_sel:[1,1,0] op_sel_hi:[1,0,1] neg_lo:[1,0,0]
    v_cvt_pk_bf16_f32 v83, v84, -v85
    ds_write_addtid_b32 v83 offset:4320
    ds_read_b128 v[88:91], v32 offset:0
    ds_read_b128 v[92:95], v32 offset:64
    ds_read_b128 v[96:99], v32 offset:128
    ds_read_b128 v[100:103], v32 offset:192
    s_add_u32 m0, s68, 16384
    s_nop 0
    buffer_load_dwordx4 v9, s[36:39], s67 offen offset:1024 lds
    s_mov_b32 m0, s70
    v_pk_mul_f32 v[80:81], v[72:73], v[72:73] op_sel:[0,0] op_sel_hi:[0,1]
    v_pk_fma_f32 v[104:105], v[72:73], v[72:73], v[80:81] op_sel:[1,1,0] op_sel_hi:[1,0,1] neg_lo:[1,0,0]
    v_pk_mul_f32 v[80:81], v[104:105], v[72:73] op_sel:[0,0] op_sel_hi:[0,1]
    v_pk_fma_f32 v[106:107], v[104:105], v[72:73], v[80:81] op_sel:[1,1,0] op_sel_hi:[1,0,1] neg_lo:[1,0,0]
    v_pk_mul_f32 v[80:81], v[104:105], v[104:105] op_sel:[0,0] op_sel_hi:[0,1]
    v_pk_fma_f32 v[108:109], v[104:105], v[104:105], v[80:81] op_sel:[1,1,0] op_sel_hi:[1,0,1] neg_lo:[1,0,0]
    v_pk_mul_f32 v[80:81], v[108:109], v[72:73] op_sel:[0,0] op_sel_hi:[0,1]
    v_pk_fma_f32 v[110:111], v[108:109], v[72:73], v[80:81] op_sel:[1,1,0] op_sel_hi:[1,0,1] neg_lo:[1,0,0]
    v_pk_mul_f32 v[80:81], v[106:107], v[106:107] op_sel:[0,0] op_sel_hi:[0,1]
    v_pk_fma_f32 v[112:113], v[106:107], v[106:107], v[80:81] op_sel:[1,1,0] op_sel_hi:[1,0,1] neg_lo:[1,0,0]
    v_pk_mul_f32 v[80:81], v[112:113], v[72:73] op_sel:[0,0] op_sel_hi:[0,1]
    v_pk_fma_f32 v[114:115], v[112:113], v[72:73], v[80:81] op_sel:[1,1,0] op_sel_hi:[1,0,1] neg_lo:[1,0,0]
    v_mov_b32 v82, 0x3f80
    ds_write_addtid_b32 v82 offset:0
    v_cvt_pk_bf16_f32 v83, v72, v73
    ds_write_addtid_b32 v83 offset:288
    v_cvt_pk_bf16_f32 v82, v104, v105
    ds_write_addtid_b32 v82 offset:576
    v_cvt_pk_bf16_f32 v83, v106, v107
    ds_write_addtid_b32 v83 offset:864
    v_cvt_pk_bf16_f32 v82, v108, v109
    ds_write_addtid_b32 v82 offset:1152
    v_cvt_pk_bf16_f32 v83, v110, v111
    ds_write_addtid_b32 v83 offset:1440
    v_cvt_pk_bf16_f32 v82, v112, v113
    ds_write_addtid_b32 v82 offset:1728
    v_cvt_pk_bf16_f32 v83, v114, v115
    ds_write_addtid_b32 v83 offset:2016
    v_cvt_pk_bf16_f32 v82, v76, v77
    ds_write_addtid_b32 v82 offset:2304
    s_add_u32 m0, s68, 16384
    s_nop 0
    buffer_load_dwordx4 v9, s[36:39], s67 offen offset:2048 lds
    s_mov_b32 m0, s70
    v_pk_mul_f32 v[80:81], v[76:77], v[72:73] op_sel:[0,0] op_sel_hi:[0,1]
    v_pk_fma_f32 v[160:161], v[76:77], v[72:73], v[80:81] op_sel:[1,1,0] op_sel_hi:[1,0,1] neg_lo:[1,0,0]
    v_cvt_pk_bf16_f32 v83, v160, v161
    ds_write_addtid_b32 v83 offset:2592
    v_pk_mul_f32 v[80:81], v[76:77], v[104:105] op_sel:[0,0] op_sel_hi:[0,1]
    v_pk_fma_f32 v[160:161], v[76:77], v[104:105], v[80:81] op_sel:[1,1,0] op_sel_hi:[1,0,1] neg_lo:[1,0,0]
    v_cvt_pk_bf16_f32 v82, v160, v161
    ds_write_addtid_b32 v82 offset:2880
    v_pk_mul_f32 v[80:81], v[76:77], v[106:107] op_sel:[0,0] op_sel_hi:[0,1]
    v_pk_fma_f32 v[160:161], v[76:77], v[106:107], v[80:81] op_sel:[1,1,0] op_sel_hi:[1,0,1] neg_lo:[1,0,0]
    v_cvt_pk_bf16_f32 v83, v160, v161
    ds_write_addtid_b32 v83 offset:3168
    v_pk_mul_f32 v[80:81], v[76:77], v[108:109] op_sel:[0,0] op_sel_hi:[0,1]
    v_pk_fma_f32 v[160:161], v[76:77], v[108:109], v[80:81] op_sel:[1,1,0] op_sel_hi:[1,0,1] neg_lo:[1,0,0]
    v_cvt_pk_bf16_f32 v82, v160, v161
    ds_write_addtid_b32 v82 offset:3456
    buffer_load_dwordx4 v[20:23], v12, s[56:59], 0 offen
    s_mov_b32 m0, s70
    v_pk_mul_f32 v[80:81], v[76:77], v[110:111] op_sel:[0,0] op_sel_hi:[0,1]
    v_pk_fma_f32 v[160:161], v[76:77], v[110:111], v[80:81] op_sel:[1,1,0] op_sel_hi:[1,0,1] neg_lo:[1,0,0]
    v_cvt_pk_bf16_f32 v83, v160, v161
    ds_write_addtid_b32 v83 offset:3744
    v_pk_mul_f32 v[80:81], v[76:77], v[112:113] op_sel:[0,0] op_sel_hi:[0,1]
    v_pk_fma_f32 v[160:161], v[76:77], v[112:113], v[80:81] op_sel:[1,1,0] op_sel_hi:[1,0,1] neg_lo:[1,0,0]
    v_cvt_pk_bf16_f32 v82, v160, v161
    ds_write_addtid_b32 v82 offset:4032
    v_pk_mul_f32 v[80:81], v[76:77], v[114:115] op_sel:[0,0] op_sel_hi:[0,1]
    v_pk_fma_f32 v[160:161], v[76:77], v[114:115], v[80:81] op_sel:[1,1,0] op_sel_hi:[1,0,1] neg_lo:[1,0,0]
    v_cvt_pk_bf16_f32 v83, v160, v161
    ds_write_addtid_b32 v83 offset:4320
    ds_read_b128 v[116:119], v32 offset:0
    ds_read_b128 v[120:123], v32 offset:64
    ds_read_b128 v[124:127], v32 offset:128
    ds_read_b128 v[128:131], v32 offset:192
    buffer_load_dwordx4 v[24:27], v12, s[56:59], 0 offen offset:64
    s_mov_b32 m0, s70
    s_lshl_b32 s30, s62, 10
    s_add_u32 m0, s30, 124928
    s_nop 0
    buffer_load_dwordx4 v13, s[40:43], 0 offen lds
    s_mov_b32 m0, s70
    s_add_u32 s66, s66, 64
    s_and_b32 s66, s66, 1023
    s_add_u32 m0, s68, 32768
    s_mul_i32 s67, s66, 1536
    buffer_load_dwordx4 v8, s[32:35], s66 offen offset:3072 lds
    s_mov_b32 m0, s70
    v_pk_mul_f32 v[80:81], v[76:77], v[76:77] op_sel:[0,0] op_sel_hi:[0,1]
    v_pk_fma_f32 v[162:163], v[76:77], v[76:77], v[80:81] op_sel:[1,1,0] op_sel_hi:[1,0,1] neg_lo:[1,0,0]
    v_cvt_pk_bf16_f32 v82, v162, v163
    ds_write_addtid_b32 v82 offset:0
    v_pk_mul_f32 v[80:81], v[162:163], v[104:105] op_sel:[0,0] op_sel_hi:[0,1]
    v_pk_fma_f32 v[160:161], v[162:163], v[104:105], v[80:81] op_sel:[1,1,0] op_sel_hi:[1,0,1] neg_lo:[1,0,0]
    v_cvt_pk_bf16_f32 v83, v160, v161
    ds_write_addtid_b32 v83 offset:288
    v_pk_mul_f32 v[80:81], v[162:163], v[108:109] op_sel:[0,0] op_sel_hi:[0,1]
    v_pk_fma_f32 v[160:161], v[162:163], v[108:109], v[80:81] op_sel:[1,1,0] op_sel_hi:[1,0,1] neg_lo:[1,0,0]
    v_cvt_pk_bf16_f32 v82, v160, v161
    ds_write_addtid_b32 v82 offset:576
    v_pk_mul_f32 v[80:81], v[162:163], v[112:113] op_sel:[0,0] op_sel_hi:[0,1]
    v_pk_fma_f32 v[160:161], v[162:163], v[112:113], v[80:81] op_sel:[1,1,0] op_sel_hi:[1,0,1] neg_lo:[1,0,0]
    v_cvt_pk_bf16_f32 v83, v160, v161
    ds_write_addtid_b32 v83 offset:864
    v_pk_mul_f32 v[80:81], v[162:163], v[76:77] op_sel:[0,0] op_sel_hi:[0,1]
    v_pk_fma_f32 v[162:163], v[162:163], v[76:77], v[80:81] op_sel:[1,1,0] op_sel_hi:[1,0,1] neg_lo:[1,0,0]
    s_add_u32 m0, s68, 32768
    s_nop 0
    buffer_load_dwordx4 v9, s[36:39], s67 offen offset:0 lds
    s_mov_b32 m0, s70
    v_cvt_pk_bf16_f32 v82, v162, v163
    ds_write_addtid_b32 v82 offset:1152
    v_pk_mul_f32 v[80:81], v[162:163], v[104:105] op_sel:[0,0] op_sel_hi:[0,1]
    v_pk_fma_f32 v[160:161], v[162:163], v[104:105], v[80:81] op_sel:[1,1,0] op_sel_hi:[1,0,1] neg_lo:[1,0,0]
    v_cvt_pk_bf16_f32 v83, v160, v161
    ds_write_addtid_b32 v83 offset:1440
    v_pk_mul_f32 v[80:81], v[162:163], v[108:109] op_sel:[0,0] op_sel_hi:[0,1]
    v_pk_fma_f32 v[160:161], v[162:163], v[108:109], v[80:81] op_sel:[1,1,0] op_sel_hi:[1,0,1] neg_lo:[1,0,0]
    v_cvt_pk_bf16_f32 v82, v160, v161
    ds_write_addtid_b32 v82 offset:1728
    v_pk_mul_f32 v[80:81], v[162:163], v[112:113] op_sel:[0,0] op_sel_hi:[0,1]
    v_pk_fma_f32 v[160:161], v[162:163], v[112:113], v[80:81] op_sel:[1,1,0] op_sel_hi:[1,0,1] neg_lo:[1,0,0]
    v_cvt_pk_bf16_f32 v83, v160, v161
    ds_write_addtid_b32 v83 offset:2016
    v_pk_mul_f32 v[80:81], v[162:163], v[76:77] op_sel:[0,0] op_sel_hi:[0,1]
    v_pk_fma_f32 v[162:163], v[162:163], v[76:77], v[80:81] op_sel:[1,1,0] op_sel_hi:[1,0,1] neg_lo:[1,0,0]
    s_add_u32 m0, s68, 32768
    s_nop 0
    buffer_load_dwordx4 v9, s[36:39], s67 offen offset:1024 lds
    s_mov_b32 m0, s70
    v_cvt_pk_bf16_f32 v82, v162, v163
    ds_write_addtid_b32 v82 offset:2304
    v_pk_mul_f32 v[80:81], v[162:163], v[108:109] op_sel:[0,0] op_sel_hi:[0,1]
    v_pk_fma_f32 v[160:161], v[162:163], v[108:109], v[80:81] op_sel:[1,1,0] op_sel_hi:[1,0,1] neg_lo:[1,0,0]
    v_cvt_pk_bf16_f32 v83, v160, v161
    ds_write_addtid_b32 v83 offset:2592
    v_pk_mul_f32 v[80:81], v[162:163], v[76:77] op_sel:[0,0] op_sel_hi:[0,1]
    v_pk_fma_f32 v[162:163], v[162:163], v[76:77], v[80:81] op_sel:[1,1,0] op_sel_hi:[1,0,1] neg_lo:[1,0,0]
    v_cvt_pk_bf16_f32 v82, v162, v163
    ds_write_addtid_b32 v82 offset:2880
    v_pk_mul_f32 v[80:81], v[162:163], v[108:109] op_sel:[0,0] op_sel_hi:[0,1]
    v_pk_fma_f32 v[160:161], v[162:163], v[108:109], v[80:81] op_sel:[1,1,0] op_sel_hi:[1,0,1] neg_lo:[1,0,0]
    v_cvt_pk_bf16_f32 v83, v160, v161
    ds_write_addtid_b32 v83 offset:3168
    v_pk_mul_f32 v[80:81], v[162:163], v[76:77] op_sel:[0,0] op_sel_hi:[0,1]
    v_pk_fma_f32 v[162:163], v[162:163], v[76:77], v[80:81] op_sel:[1,1,0] op_sel_hi:[1,0,1] neg_lo:[1,0,0]
    s_add_u32 m0, s68, 32768
    s_nop 0
    buffer_load_dwordx4 v9, s[36:39], s67 offen offset:2048 lds
    s_mov_b32 m0, s70
    v_cvt_pk_bf16_f32 v82, v162, v163
    ds_write_addtid_b32 v82 offset:3456
    v_pk_mul_f32 v[80:81], v[162:163], v[108:109] op_sel:[0,0] op_sel_hi:[0,1]
    v_pk_fma_f32 v[160:161], v[162:163], v[108:109], v[80:81] op_sel:[1,1,0] op_sel_hi:[1,0,1] neg_lo:[1,0,0]
    v_cvt_pk_bf16_f32 v83, v160, v161
    ds_write_addtid_b32 v83 offset:3744
    v_pk_mul_f32 v[80:81], v[162:163], v[76:77] op_sel:[0,0] op_sel_hi:[0,1]
    v_pk_fma_f32 v[162:163], v[162:163], v[76:77], v[80:81] op_sel:[1,1,0] op_sel_hi:[1,0,1] neg_lo:[1,0,0]
    v_cvt_pk_bf16_f32 v82, v162, v163
    ds_write_addtid_b32 v82 offset:4032
    v_pk_mul_f32 v[80:81], v[162:163], v[108:109] op_sel:[0,0] op_sel_hi:[0,1]
    v_pk_fma_f32 v[160:161], v[162:163], v[108:109], v[80:81] op_sel:[1,1,0] op_sel_hi:[1,0,1] neg_lo:[1,0,0]
    v_cvt_pk_bf16_f32 v83, v160, v161
    ds_write_addtid_b32 v83 offset:4320
    v_pk_mul_f32 v[80:81], v[162:163], v[76:77] op_sel:[0,0] op_sel_hi:[0,1]
    v_pk_fma_f32 v[162:163], v[162:163], v[76:77], v[80:81] op_sel:[1,1,0] op_sel_hi:[1,0,1] neg_lo:[1,0,0]
    s_add_u32 s66, s66, 64
    s_and_b32 s66, s66, 1023
    s_add_u32 m0, s68, 49152
    s_mul_i32 s67, s66, 1536
    buffer_load_dwordx4 v8, s[32:35], s66 offen offset:3072 lds
    s_mov_b32 m0, s70
    ds_read_b128 v[132:135], v32 offset:0
    ds_read_b128 v[136:139], v32 offset:64
    ds_read_b128 v[140:143], v32 offset:128
    ds_read_b128 v[144:147], v32 offset:192
    s_waitcnt lgkmcnt(4)
    v_mfma_f32_16x16x32_bf16 v[148:151], v[116:119], v[88:91], 0
    v_mfma_f32_16x16x32_bf16 v[148:151], v[120:123], v[92:95], v[148:151]
    v_mfma_f32_16x16x32_bf16 v[148:151], v[124:127], v[96:99], v[148:151]
    v_mfma_f32_16x16x32_bf16 v[148:151], v[128:131], v[100:103], v[148:151]
    v_cvt_pk_bf16_f32 v82, v162, v163
    ds_write_addtid_b32 v82 offset:0
    v_pk_mul_f32 v[80:81], v[162:163], v[76:77] op_sel:[0,0] op_sel_hi:[0,1]
    v_pk_fma_f32 v[162:163], v[162:163], v[76:77], v[80:81] op_sel:[1,1,0] op_sel_hi:[1,0,1] neg_lo:[1,0,0]
    v_cvt_pk_bf16_f32 v83, v162, v163
    ds_write_addtid_b32 v83 offset:288
    v_pk_mul_f32 v[80:81], v[162:163], v[76:77] op_sel:[0,0] op_sel_hi:[0,1]
    v_pk_fma_f32 v[162:163], v[162:163], v[76:77], v[80:81] op_sel:[1,1,0] op_sel_hi:[1,0,1] neg_lo:[1,0,0]
    v_cvt_pk_bf16_f32 v82, v162, v163
    ds_write_addtid_b32 v82 offset:576
    v_pk_mul_f32 v[80:81], v[162:163], v[76:77] op_sel:[0,0] op_sel_hi:[0,1]
    v_pk_fma_f32 v[162:163], v[162:163], v[76:77], v[80:81] op_sel:[1,1,0] op_sel_hi:[1,0,1] neg_lo:[1,0,0]
    v_cvt_pk_bf16_f32 v83, v162, v163
    ds_write_addtid_b32 v83 offset:864
    v_pk_mul_f32 v[80:81], v[162:163], v[76:77] op_sel:[0,0] op_sel_hi:[0,1]
    v_pk_fma_f32 v[162:163], v[162:163], v[76:77], v[80:81] op_sel:[1,1,0] op_sel_hi:[1,0,1] neg_lo:[1,0,0]
    s_add_u32 m0, s68, 49152
    s_nop 0
    buffer_load_dwordx4 v9, s[36:39], s67 offen offset:0 lds
    s_mov_b32 m0, s70
    v_cvt_pk_bf16_f32 v82, v162, v163
    ds_write_addtid_b32 v82 offset:1152
    v_pk_mul_f32 v[80:81], v[162:163], v[76:77] op_sel:[0,0] op_sel_hi:[0,1]
    v_pk_fma_f32 v[162:163], v[162:163], v[76:77], v[80:81] op_sel:[1,1,0] op_sel_hi:[1,0,1] neg_lo:[1,0,0]
    v_cvt_pk_bf16_f32 v83, v162, v163
    ds_write_addtid_b32 v83 offset:1440
    v_pk_mul_f32 v[80:81], v[162:163], v[76:77] op_sel:[0,0] op_sel_hi:[0,1]
    v_pk_fma_f32 v[162:163], v[162:163], v[76:77], v[80:81] op_sel:[1,1,0] op_sel_hi:[1,0,1] neg_lo:[1,0,0]
    v_cvt_pk_bf16_f32 v82, v162, v163
    ds_write_addtid_b32 v82 offset:1728
    v_pk_mul_f32 v[80:81], v[162:163], v[76:77] op_sel:[0,0] op_sel_hi:[0,1]
    v_pk_fma_f32 v[162:163], v[162:163], v[76:77], v[80:81] op_sel:[1,1,0] op_sel_hi:[1,0,1] neg_lo:[1,0,0]
    v_cvt_pk_bf16_f32 v83, v162, v163
    ds_write_addtid_b32 v83 offset:2016
    v_pk_mul_f32 v[80:81], v[162:163], v[76:77] op_sel:[0,0] op_sel_hi:[0,1]
    v_pk_fma_f32 v[162:163], v[162:163], v[76:77], v[80:81] op_sel:[1,1,0] op_sel_hi:[1,0,1] neg_lo:[1,0,0]
    s_add_u32 m0, s68, 49152
    s_nop 0
    buffer_load_dwordx4 v9, s[36:39], s67 offen offset:1024 lds
    s_mov_b32 m0, s70
    v_cvt_pk_bf16_f32 v82, v162, v163
    ds_write_addtid_b32 v82 offset:2304
    s_waitcnt lgkmcnt(9)
    v_mfma_f32_16x16x32_bf16 v[152:155], v[132:135], v[88:91], 0
    v_mfma_f32_16x16x32_bf16 v[152:155], v[136:139], v[92:95], v[152:155]
    v_mfma_f32_16x16x32_bf16 v[152:155], v[140:143], v[96:99], v[152:155]
    v_mfma_f32_16x16x32_bf16 v[152:155], v[144:147], v[100:103], v[152:155]
    ds_read_b128 v[116:119], v32 offset:0
    ds_read_b128 v[120:123], v32 offset:64
    ds_read_b128 v[124:127], v32 offset:128
    ds_read_b128 v[128:131], v32 offset:192
    s_waitcnt lgkmcnt(0)
    v_mfma_f32_16x16x32_bf16 v[156:159], v[116:119], v[88:91], 0
    v_mfma_f32_16x16x32_bf16 v[156:159], v[120:123], v[92:95], v[156:159]
    v_mfma_f32_16x16x32_bf16 v[156:159], v[124:127], v[96:99], v[156:159]
    v_mfma_f32_16x16x32_bf16 v[156:159], v[128:131], v[100:103], v[156:159]
    s_add_u32 m0, s68, 49152
    s_nop 0
    buffer_load_dwordx4 v9, s[36:39], s67 offen offset:2048 lds
    s_mov_b32 m0, s70
    ds_write_b128 v41, v[148:151] offset:0
    ds_write_b128 v41, v[152:155] offset:1024
    s_nop 1
    ds_write_b128 v41, v[156:159] offset:2048
    v_mov_b32 v28, 0
    buffer_load_dword v29, v28, s[80:83], 0 offen sc1
    s_waitcnt vmcnt(12) lgkmcnt(0)
    s_barrier
    ds_read_b64_tr_b16 v[132:133], v35 offset:0
    ds_read_b64_tr_b16 v[134:135], v36 offset:0
    ds_read_b64_tr_b16 v[136:137], v35 offset:8192
    ds_read_b64_tr_b16 v[138:139], v36 offset:8192
    ds_read_b128 v[116:119], v42 offset:0
    ds_read_b128 v[120:123], v42 offset:1024
    ds_read_b128 v[124:127], v42 offset:2048
    ds_read_b128 v[140:143], v40
    ds_read_b128 v[144:147], v40 offset:16384
    s_add_u32 s66, s66, 64
    s_and_b32 s66, s66, 1023
    s_add_u32 m0, s68, 65536
    s_mul_i32 s67, s66, 1536
    buffer_load_dwordx4 v8, s[32:35], s66 offen offset:3072 lds
    s_mov_b32 m0, s70
    s_add_u32 m0, s68, 65536
    s_nop 0
    buffer_load_dwordx4 v9, s[36:39], s67 offen offset:0 lds
    s_mov_b32 m0, s70
    s_add_u32 m0, s68, 65536
    s_nop 0
    buffer_load_dwordx4 v9, s[36:39], s67 offen offset:1024 lds
    s_mov_b32 m0, s70
    s_add_u32 m0, s68, 65536
    s_nop 0
    buffer_load_dwordx4 v9, s[36:39], s67 offen offset:2048 lds
    s_mov_b32 m0, s70
    s_waitcnt lgkmcnt(5)
    ds_write_b128 v37, v[132:135]
    v_xor_b32 v4, 64, v37
    ds_write_b128 v4, v[136:139]
    ds_read_b128 v[132:135], v38
    ds_read_b128 v[136:139], v38 offset:1024
    v_cmp_eq_u32 vcc, s63, v33
    s_waitcnt lgkmcnt(6)
    v_pk_add_f32 v[148:149], v[148:149], v[116:117]
    v_pk_add_f32 v[150:151], v[150:151], v[118:119]
    v_pk_add_f32 v[152:153], v[152:153], v[120:121]
    v_pk_add_f32 v[154:155], v[154:155], v[122:123]
    v_pk_add_f32 v[156:157], v[156:157], v[124:125]
    v_pk_add_f32 v[158:159], v[158:159], v[126:127]
    v_lshlrev_b32 v19, 16, v19
    v_add_f32 v19, v148, v19
    v_cmp_eq_u32 s[6:7], 0, v2
    s_nop 1
    v_cndmask_b32 v148, v148, v19, s[6:7]
    s_and_saveexec_b64 s[4:5], vcc
    ds_write_b128 v43, v[148:151] offset:0
    ds_write_b128 v43, v[152:155] offset:1024
    ds_write_b128 v43, v[156:159] offset:2048
    s_mov_b64 exec, 1
    ds_write_b64 v43, v[66:67] offset:3072
    s_mov_b64 exec, s[4:5]
    v_mov_b32 v164, 0
    s_waitcnt vmcnt(14) lgkmcnt(8)
    v_dot2c_f32_bf16 v164, v140, v20
    v_dot2c_f32_bf16 v164, v141, v21
    v_dot2c_f32_bf16 v164, v142, v22
    v_dot2c_f32_bf16 v164, v143, v23
    v_dot2c_f32_bf16 v164, v144, v24
    v_dot2c_f32_bf16 v164, v145, v25
    v_dot2c_f32_bf16 v164, v146, v26
    v_dot2c_f32_bf16 v164, v147, v27
    v_and_b32 v5, 3, v2
    v_cmp_eq_u32 vcc, 0, v5
    s_mov_b32 s30, 32768
    s_waitcnt lgkmcnt(4)
    buffer_store_dwordx4 v[132:135], v39, s[44:47], 0 offen sc1
    buffer_store_dwordx4 v[136:139], v39, s[44:47], s30 offen sc1
    v_add_f32_dpp v164, v164, v164 quad_perm:[1,0,3,2] row_mask:0xf bank_mask:0xf
    s_nop 1
    v_add_f32_dpp v164, v164, v164 quad_perm:[2,3,0,1] row_mask:0xf bank_mask:0xf
    s_and_saveexec_b64 s[4:5], vcc
    buffer_store_dword v164, v44, s[44:47], 0 offen sc1
    s_mov_b64 exec, s[4:5]
    s_waitcnt vmcnt(7)
    s_mov_b32 s90, 0
LF_tag_loop:
    v_readfirstlane_b32 s93, v29
    s_add_u32 s90, s90, 1
    s_cmp_lg_u32 s93, 0
    s_cbranch_scc1 LF_tag_done
    s_sleep 4
    buffer_load_dword v29, v28, s[80:83], 0 offen sc1
    s_waitcnt vmcnt(0)
    s_cmp_lt_u32 s90, 65536
    s_cbranch_scc1 LF_tag_loop
LF_tag_done:
    s_waitcnt vmcnt(23) lgkmcnt(0)
    s_barrier
    ds_read_b128 v[116:119], v45 offset:0
    ds_read_b64_tr_b16 v[124:125], v47 offset:1024
    ds_read_b64_tr_b16 v[126:127], v47 offset:1536
    ds_read_b64_tr_b16 v[120:121], v47 offset:0
    ds_read_b64_tr_b16 v[122:123], v47 offset:512
    ds_read_b64_tr_b16 v[128:129], v48 offset:2048
    ds_read_b64_tr_b16 v[130:131], v48 offset:2560
    s_add_u32 s66, s66, 64
    s_and_b32 s66, s66, 1023
    s_add_u32 m0, s68, 81920
    s_mul_i32 s67, s66, 1536
    buffer_load_dwordx4 v8, s[32:35], s66 offen offset:3072 lds
    ds_read_b128 v[132:135], v46 offset:0
    ds_read_b64_tr_b16 v[140:141], v47 offset:9216
    ds_read_b64_tr_b16 v[142:143], v47 offset:9728
    buffer_load_dwordx4 v9, s[36:39], s67 offen offset:0 lds
    s_waitcnt lgkmcnt(7)
    v_mfma_f32_32x32x16_bf16 v[84:99], v[124:127], v[116:119], 0
    ds_read_b64_tr_b16 v[136:137], v47 offset:8192
    ds_read_b64_tr_b16 v[138:139], v47 offset:8704
    buffer_load_dwordx4 v9, s[36:39], s67 offen offset:1024 lds
    s_waitcnt lgkmcnt(7)
    v_mfma_f32_32x32x16_bf16 v[68:83], v[120:123], v[116:119], 0
    ds_read_b64_tr_b16 v[144:145], v48 offset:10240
    ds_read_b64_tr_b16 v[146:147], v48 offset:10752
    buffer_load_dwordx4 v9, s[36:39], s67 offen offset:2048 lds
    s_waitcnt lgkmcnt(7)
    v_mfma_f32_32x32x16_bf16 v[100:115], v[116:119], v[128:131], 0
    s_waitcnt vmcnt(23) lgkmcnt(0)
    s_barrier
    v_mfma_f32_32x32x16_bf16 v[84:99], v[140:143], v[132:135], v[84:99]
    ds_read_b128 v[116:119], v45 offset:16384
    ds_read_b64_tr_b16 v[124:125], v47 offset:17408
    ds_read_b64_tr_b16 v[126:127], v47 offset:17920
    v_mfma_f32_32x32x16_bf16 v[68:83], v[136:139], v[132:135], v[68:83]
    ds_read_b64_tr_b16 v[120:121], v47 offset:16384
    ds_read_b64_tr_b16 v[122:123], v47 offset:16896
    ds_read_b64_tr_b16 v[128:129], v48 offset:18432
    ds_read_b64_tr_b16 v[130:131], v48 offset:18944
    v_mfma_f32_32x32x16_bf16 v[100:115], v[132:135], v[144:147], v[100:115]
    s_add_u32 s66, s66, 64
    s_and_b32 s66, s66, 1023
    s_add_u32 m0, s68, 0
    s_mul_i32 s67, s66, 1536
    buffer_load_dwordx4 v8, s[32:35], s66 offen offset:3072 lds
    ds_read_b128 v[132:135], v46 offset:16384
    ds_read_b64_tr_b16 v[140:141], v47 offset:25600
    ds_read_b64_tr_b16 v[142:143], v47 offset:26112
    buffer_load_dwordx4 v9, s[36:39], s67 offen offset:0 lds
    s_waitcnt lgkmcnt(7)
    v_mfma_f32_32x32x16_bf16 v[84:99], v[124:127], v[116:119], v[84:99]
    ds_read_b64_tr_b16 v[136:137], v47 offset:24576
    ds_read_b64_tr_b16 v[138:139], v47 offset:25088
    buffer_load_dwordx4 v9, s[36:39], s67 offen offset:1024 lds
    s_waitcnt lgkmcnt(7)
    v_mfma_f32_32x32x16_bf16 v[68:83], v[120:123], v[116:119], v[68:83]
    ds_read_b64_tr_b16 v[144:145], v48 offset:26624
    ds_read_b64_tr_b16 v[146:147], v48 offset:27136
    buffer_load_dwordx4 v9, s[36:39], s67 offen offset:2048 lds
    s_waitcnt lgkmcnt(7)
    v_mfma_f32_32x32x16_bf16 v[100:115], v[116:119], v[128:131], v[100:115]
    s_waitcnt vmcnt(20) lgkmcnt(0)
    s_barrier
    v_mfma_f32_32x32x16_bf16 v[84:99], v[140:143], v[132:135], v[84:99]
    ds_read_b128 v[116:119], v45 offset:32768
    ds_read_b64_tr_b16 v[124:125], v47 offset:33792
    ds_read_b64_tr_b16 v[126:127], v47 offset:34304
    v_mfma_f32_32x32x16_bf16 v[68:83], v[136:139], v[132:135], v[68:83]
    ds_read_b64_tr_b16 v[120:121], v47 offset:32768
    ds_read_b64_tr_b16 v[122:123], v47 offset:33280
    ds_read_b64_tr_b16 v[128:129], v48 offset:34816
    ds_read_b64_tr_b16 v[130:131], v48 offset:35328
    v_mfma_f32_32x32x16_bf16 v[100:115], v[132:135], v[144:147], v[100:115]
    s_add_u32 s66, s66, 64
    s_and_b32 s66, s66, 1023
    s_add_u32 m0, s68, 16384
    s_mul_i32 s67, s66, 1536
    buffer_load_dwordx4 v8, s[32:35], s66 offen offset:3072 lds
    ds_read_b128 v[132:135], v46 offset:32768
    ds_read_b64_tr_b16 v[140:141], v47 offset:41984
    ds_read_b64_tr_b16 v[142:143], v47 offset:42496
    buffer_load_dwordx4 v9, s[36:39], s67 offen offset:0 lds
    s_waitcnt lgkmcnt(7)
    v_mfma_f32_32x32x16_bf16 v[84:99], v[124:127], v[116:119], v[84:99]
    ds_read_b64_tr_b16 v[136:137], v47 offset:40960
    ds_read_b64_tr_b16 v[138:139], v47 offset:41472
    buffer_load_dwordx4 v9, s[36:39], s67 offen offset:1024 lds
    s_waitcnt lgkmcnt(7)
    v_mfma_f32_32x32x16_bf16 v[68:83], v[120:123], v[116:119], v[68:83]
    ds_read_b64_tr_b16 v[144:145], v48 offset:43008
    ds_read_b64_tr_b16 v[146:147], v48 offset:43520
    buffer_load_dwordx4 v9, s[36:39], s67 offen offset:2048 lds
    s_waitcnt lgkmcnt(7)
    v_mfma_f32_32x32x16_bf16 v[100:115], v[116:119], v[128:131], v[100:115]
    s_waitcnt vmcnt(20) lgkmcnt(0)
    s_barrier
    v_mfma_f32_32x32x16_bf16 v[84:99], v[140:143], v[132:135], v[84:99]
    ds_read_b128 v[116:119], v45 offset:49152
    ds_read_b64_tr_b16 v[124:125], v47 offset:50176
    ds_read_b64_tr_b16 v[126:127], v47 offset:50688
    v_mfma_f32_32x32x16_bf16 v[68:83], v[136:139], v[132:135], v[68:83]
    ds_read_b64_tr_b16 v[120:121], v47 offset:49152
    ds_read_b64_tr_b16 v[122:123], v47 offset:49664
    ds_read_b64_tr_b16 v[128:129], v48 offset:51200
    ds_read_b64_tr_b16 v[130:131], v48 offset:51712
    v_mfma_f32_32x32x16_bf16 v[100:115], v[132:135], v[144:147], v[100:115]
    s_add_u32 s66, s66, 64
    s_and_b32 s66, s66, 1023
    s_add_u32 m0, s68, 32768
    s_mul_i32 s67, s66, 1536
    buffer_load_dwordx4 v8, s[32:35], s66 offen offset:3072 lds
    ds_read_b128 v[132:135], v46 offset:49152
    ds_read_b64_tr_b16 v[140:141], v47 offset:58368
    ds_read_b64_tr_b16 v[142:143], v47 offset:58880
    buffer_load_dwordx4 v9, s[36:39], s67 offen offset:0 lds
    s_waitcnt lgkmcnt(7)
    v_mfma_f32_32x32x16_bf16 v[84:99], v[124:127], v[116:119], v[84:99]
    ds_read_b64_tr_b16 v[136:137], v47 offset:57344
    ds_read_b64_tr_b16 v[138:139], v47 offset:57856
    buffer_load_dwordx4 v9, s[36:39], s67 offen offset:1024 lds
    s_waitcnt lgkmcnt(7)
    v_mfma_f32_32x32x16_bf16 v[68:83], v[120:123], v[116:119], v[68:83]
    ds_read_b64_tr_b16 v[144:145], v48 offset:59392
    ds_read_b64_tr_b16 v[146:147], v48 offset:59904
    buffer_load_dwordx4 v9, s[36:39], s67 offen offset:2048 lds
    s_waitcnt lgkmcnt(7)
    v_mfma_f32_32x32x16_bf16 v[100:115], v[116:119], v[128:131], v[100:115]
    s_waitcnt vmcnt(19) lgkmcnt(0)
    s_barrier
    v_mfma_f32_32x32x16_bf16 v[84:99], v[140:143], v[132:135], v[84:99]
    ds_read_b128 v[116:119], v49 offset:0
    ds_read_b64_tr_b16 v[124:125], v51 offset:1024
    ds_read_b64_tr_b16 v[126:127], v51 offset:1536
    v_mfma_f32_32x32x16_bf16 v[68:83], v[136:139], v[132:135], v[68:83]
    ds_read_b64_tr_b16 v[120:121], v51 offset:0
    ds_read_b64_tr_b16 v[122:123], v51 offset:512
    ds_read_b64_tr_b16 v[128:129], v52 offset:2048
    ds_read_b64_tr_b16 v[130:131], v52 offset:2560
    v_mfma_f32_32x32x16_bf16 v[100:115], v[132:135], v[144:147], v[100:115]
    s_add_u32 s66, s66, 64
    s_and_b32 s66, s66, 1023
    s_add_u32 m0, s68, 49152
    s_mul_i32 s67, s66, 1536
    buffer_load_dwordx4 v8, s[32:35], s66 offen offset:3072 lds
    ds_read_b128 v[132:135], v50 offset:0
    ds_read_b64_tr_b16 v[140:141], v51 offset:9216
    ds_read_b64_tr_b16 v[142:143], v51 offset:9728
    buffer_load_dwordx4 v9, s[36:39], s67 offen offset:0 lds
    s_waitcnt lgkmcnt(7)
    v_mfma_f32_32x32x16_bf16 v[84:99], v[124:127], v[116:119], v[84:99]
    ds_read_b64_tr_b16 v[136:137], v51 offset:8192
    ds_read_b64_tr_b16 v[138:139], v51 offset:8704
    buffer_load_dwordx4 v9, s[36:39], s67 offen offset:1024 lds
    s_waitcnt lgkmcnt(7)
    v_mfma_f32_32x32x16_bf16 v[68:83], v[120:123], v[116:119], v[68:83]
    ds_read_b64_tr_b16 v[144:145], v52 offset:10240
    ds_read_b64_tr_b16 v[146:147], v52 offset:10752
    buffer_load_dwordx4 v9, s[36:39], s67 offen offset:2048 lds
    s_waitcnt lgkmcnt(7)
    v_mfma_f32_32x32x16_bf16 v[100:115], v[116:119], v[128:131], v[100:115]
    s_waitcnt vmcnt(20)
    s_waitcnt vmcnt(16) lgkmcnt(0)
    s_barrier
    v_mfma_f32_32x32x16_bf16 v[84:99], v[140:143], v[132:135], v[84:99]
    ds_read_b128 v[116:119], v49 offset:16384
    ds_read_b64_tr_b16 v[124:125], v51 offset:17408
    ds_read_b64_tr_b16 v[126:127], v51 offset:17920
    v_mfma_f32_32x32x16_bf16 v[68:83], v[136:139], v[132:135], v[68:83]
    ds_read_b64_tr_b16 v[120:121], v51 offset:16384
    ds_read_b64_tr_b16 v[122:123], v51 offset:16896
    ds_read_b64_tr_b16 v[128:129], v52 offset:18432
    ds_read_b64_tr_b16 v[130:131], v52 offset:18944
    v_mfma_f32_32x32x16_bf16 v[100:115], v[132:135], v[144:147], v[100:115]
    s_add_u32 s66, s66, 64
    s_and_b32 s66, s66, 1023
    s_add_u32 m0, s68, 65536
    s_mul_i32 s67, s66, 1536
    buffer_load_dwordx4 v8, s[32:35], s66 offen offset:3072 lds
    ds_read_b128 v[132:135], v50 offset:16384
    ds_read_b64_tr_b16 v[140:141], v51 offset:25600
    ds_read_b64_tr_b16 v[142:143], v51 offset:26112
    buffer_load_dwordx4 v9, s[36:39], s67 offen offset:0 lds
    s_waitcnt lgkmcnt(7)
    v_mfma_f32_32x32x16_bf16 v[84:99], v[124:127], v[116:119], v[84:99]
    ds_read_b64_tr_b16 v[136:137], v51 offset:24576
    ds_read_b64_tr_b16 v[138:139], v51 offset:25088
    buffer_load_dwordx4 v9, s[36:39], s67 offen offset:1024 lds
    s_waitcnt lgkmcnt(7)
    v_mfma_f32_32x32x16_bf16 v[68:83], v[120:123], v[116:119], v[68:83]
    ds_read_b64_tr_b16 v[144:145], v52 offset:26624
    ds_read_b64_tr_b16 v[146:147], v52 offset:27136
    buffer_load_dwordx4 v9, s[36:39], s67 offen offset:2048 lds
    s_waitcnt lgkmcnt(7)
    v_mfma_f32_32x32x16_bf16 v[100:115], v[116:119], v[128:131], v[100:115]
    s_cmp_eq_u32 s62, 0
    s_cbranch_scc0 LF_sig_x
    s_mov_b64 exec, 1
    v_mov_b32 v6, s93
    v_mov_b32 v7, 0
    buffer_store_dword v6, v7, s[44:47], s84 offen sc1
    s_mov_b64 exec, -1
LF_sig_x:
    s_waitcnt vmcnt(16) lgkmcnt(0)
    s_barrier
    v_mfma_f32_32x32x16_bf16 v[84:99], v[140:143], v[132:135], v[84:99]
    ds_read_b128 v[116:119], v45 offset:0
    ds_read_b64_tr_b16 v[124:125], v47 offset:1024
    ds_read_b64_tr_b16 v[126:127], v47 offset:1536
    v_mfma_f32_32x32x16_bf16 v[68:83], v[136:139], v[132:135], v[68:83]
    ds_read_b64_tr_b16 v[120:121], v47 offset:0
    ds_read_b64_tr_b16 v[122:123], v47 offset:512
    ds_read_b64_tr_b16 v[128:129], v48 offset:2048
    ds_read_b64_tr_b16 v[130:131], v48 offset:2560
    v_mfma_f32_32x32x16_bf16 v[100:115], v[132:135], v[144:147], v[100:115]
    s_add_u32 s66, s66, 64
    s_and_b32 s66, s66, 1023
    s_add_u32 m0, s68, 81920
    s_mul_i32 s67, s66, 1536
    buffer_load_dwordx4 v8, s[32:35], s66 offen offset:3072 lds
    ds_read_b128 v[132:135], v46 offset:0
    ds_read_b64_tr_b16 v[140:141], v47 offset:9216
    ds_read_b64_tr_b16 v[142:143], v47 offset:9728
    buffer_load_dwordx4 v9, s[36:39], s67 offen offset:0 lds
    s_waitcnt lgkmcnt(7)
    v_mfma_f32_32x32x16_bf16 v[84:99], v[124:127], v[116:119], v[84:99]
    ds_read_b64_tr_b16 v[136:137], v47 offset:8192
    ds_read_b64_tr_b16 v[138:139], v47 offset:8704
    buffer_load_dwordx4 v9, s[36:39], s67 offen offset:1024 lds
    s_waitcnt lgkmcnt(7)
    v_mfma_f32_32x32x16_bf16 v[68:83], v[120:123], v[116:119], v[68:83]
    ds_read_b64_tr_b16 v[144:145], v48 offset:10240
    ds_read_b64_tr_b16 v[146:147], v48 offset:10752
    buffer_load_dwordx4 v9, s[36:39], s67 offen offset:2048 lds
    s_waitcnt lgkmcnt(7)
    v_mfma_f32_32x32x16_bf16 v[100:115], v[116:119], v[128:131], v[100:115]
    s_waitcnt vmcnt(16) lgkmcnt(0)
    s_barrier
    v_mfma_f32_32x32x16_bf16 v[84:99], v[140:143], v[132:135], v[84:99]
    ds_read_b128 v[116:119], v45 offset:16384
    ds_read_b64_tr_b16 v[124:125], v47 offset:17408
    ds_read_b64_tr_b16 v[126:127], v47 offset:17920
    v_mfma_f32_32x32x16_bf16 v[68:83], v[136:139], v[132:135], v[68:83]
    ds_read_b64_tr_b16 v[120:121], v47 offset:16384
    ds_read_b64_tr_b16 v[122:123], v47 offset:16896
    ds_read_b64_tr_b16 v[128:129], v48 offset:18432
    ds_read_b64_tr_b16 v[130:131], v48 offset:18944
    v_mfma_f32_32x32x16_bf16 v[100:115], v[132:135], v[144:147], v[100:115]
    s_add_u32 s66, s66, 64
    s_and_b32 s66, s66, 1023
    s_add_u32 m0, s68, 0
    s_mul_i32 s67, s66, 1536
    buffer_load_dwordx4 v8, s[32:35], s66 offen offset:3072 lds
    ds_read_b128 v[132:135], v46 offset:16384
    ds_read_b64_tr_b16 v[140:141], v47 offset:25600
    ds_read_b64_tr_b16 v[142:143], v47 offset:26112
    buffer_load_dwordx4 v9, s[36:39], s67 offen offset:0 lds
    s_waitcnt lgkmcnt(7)
    v_mfma_f32_32x32x16_bf16 v[84:99], v[124:127], v[116:119], v[84:99]
    ds_read_b64_tr_b16 v[136:137], v47 offset:24576
    ds_read_b64_tr_b16 v[138:139], v47 offset:25088
    buffer_load_dwordx4 v9, s[36:39], s67 offen offset:1024 lds
    s_waitcnt lgkmcnt(7)
    v_mfma_f32_32x32x16_bf16 v[68:83], v[120:123], v[116:119], v[68:83]
    ds_read_b64_tr_b16 v[144:145], v48 offset:26624
    ds_read_b64_tr_b16 v[146:147], v48 offset:27136
    buffer_load_dwordx4 v9, s[36:39], s67 offen offset:2048 lds
    s_waitcnt lgkmcnt(7)
    v_mfma_f32_32x32x16_bf16 v[100:115], v[116:119], v[128:131], v[100:115]
    s_waitcnt vmcnt(16) lgkmcnt(0)
    s_barrier
    v_mfma_f32_32x32x16_bf16 v[84:99], v[140:143], v[132:135], v[84:99]
    ds_read_b128 v[116:119], v45 offset:32768
    ds_read_b64_tr_b16 v[124:125], v47 offset:33792
    ds_read_b64_tr_b16 v[126:127], v47 offset:34304
    v_mfma_f32_32x32x16_bf16 v[68:83], v[136:139], v[132:135], v[68:83]
    ds_read_b64_tr_b16 v[120:121], v47 offset:32768
    ds_read_b64_tr_b16 v[122:123], v47 offset:33280
    ds_read_b64_tr_b16 v[128:129], v48 offset:34816
    ds_read_b64_tr_b16 v[130:131], v48 offset:35328
    v_mfma_f32_32x32x16_bf16 v[100:115], v[132:135], v[144:147], v[100:115]
    s_add_u32 s66, s66, 64
    s_and_b32 s66, s66, 1023
    s_add_u32 m0, s68, 16384
    s_mul_i32 s67, s66, 1536
    buffer_load_dwordx4 v8, s[32:35], s66 offen offset:3072 lds
    ds_read_b128 v[132:135], v46 offset:32768
    ds_read_b64_tr_b16 v[140:141], v47 offset:41984
    ds_read_b64_tr_b16 v[142:143], v47 offset:42496
    buffer_load_dwordx4 v9, s[36:39], s67 offen offset:0 lds
    s_waitcnt lgkmcnt(7)
    v_mfma_f32_32x32x16_bf16 v[84:99], v[124:127], v[116:119], v[84:99]
    ds_read_b64_tr_b16 v[136:137], v47 offset:40960
    ds_read_b64_tr_b16 v[138:139], v47 offset:41472
    buffer_load_dwordx4 v9, s[36:39], s67 offen offset:1024 lds
    s_waitcnt lgkmcnt(7)
    v_mfma_f32_32x32x16_bf16 v[68:83], v[120:123], v[116:119], v[68:83]
    ds_read_b64_tr_b16 v[144:145], v48 offset:43008
    ds_read_b64_tr_b16 v[146:147], v48 offset:43520
    buffer_load_dwordx4 v9, s[36:39], s67 offen offset:2048 lds
    s_waitcnt lgkmcnt(7)
    v_mfma_f32_32x32x16_bf16 v[100:115], v[116:119], v[128:131], v[100:115]
    s_waitcnt vmcnt(16) lgkmcnt(0)
    s_barrier
    v_mfma_f32_32x32x16_bf16 v[84:99], v[140:143], v[132:135], v[84:99]
    ds_read_b128 v[116:119], v45 offset:49152
    ds_read_b64_tr_b16 v[124:125], v47 offset:50176
    ds_read_b64_tr_b16 v[126:127], v47 offset:50688
    v_mfma_f32_32x32x16_bf16 v[68:83], v[136:139], v[132:135], v[68:83]
    ds_read_b64_tr_b16 v[120:121], v47 offset:49152
    ds_read_b64_tr_b16 v[122:123], v47 offset:49664
    ds_read_b64_tr_b16 v[128:129], v48 offset:51200
    ds_read_b64_tr_b16 v[130:131], v48 offset:51712
    v_mfma_f32_32x32x16_bf16 v[100:115], v[132:135], v[144:147], v[100:115]
    s_add_u32 s66, s66, 64
    s_and_b32 s66, s66, 1023
    s_add_u32 m0, s68, 32768
    s_mul_i32 s67, s66, 1536
    buffer_load_dwordx4 v8, s[32:35], s66 offen offset:3072 lds
    ds_read_b128 v[132:135], v46 offset:49152
    ds_read_b64_tr_b16 v[140:141], v47 offset:58368
    ds_read_b64_tr_b16 v[142:143], v47 offset:58880
    buffer_load_dwordx4 v9, s[36:39], s67 offen offset:0 lds
    s_waitcnt lgkmcnt(7)
    v_mfma_f32_32x32x16_bf16 v[84:99], v[124:127], v[116:119], v[84:99]
    ds_read_b64_tr_b16 v[136:137], v47 offset:57344
    ds_read_b64_tr_b16 v[138:139], v47 offset:57856
    buffer_load_dwordx4 v9, s[36:39], s67 offen offset:1024 lds
    s_waitcnt lgkmcnt(7)
    v_mfma_f32_32x32x16_bf16 v[68:83], v[120:123], v[116:119], v[68:83]
    ds_read_b64_tr_b16 v[144:145], v48 offset:59392
    ds_read_b64_tr_b16 v[146:147], v48 offset:59904
    buffer_load_dwordx4 v9, s[36:39], s67 offen offset:2048 lds
    s_waitcnt lgkmcnt(7)
    v_mfma_f32_32x32x16_bf16 v[100:115], v[116:119], v[128:131], v[100:115]
    s_waitcnt vmcnt(16) lgkmcnt(0)
    s_barrier
    v_mfma_f32_32x32x16_bf16 v[84:99], v[140:143], v[132:135], v[84:99]
    ds_read_b128 v[116:119], v49 offset:0
    ds_read_b64_tr_b16 v[124:125], v51 offset:1024
    ds_read_b64_tr_b16 v[126:127], v51 offset:1536
    v_mfma_f32_32x32x16_bf16 v[68:83], v[136:139], v[132:135], v[68:83]
    ds_read_b64_tr_b16 v[120:121], v51 offset:0
    ds_read_b64_tr_b16 v[122:123], v51 offset:512
    ds_read_b64_tr_b16 v[128:129], v52 offset:2048
    ds_read_b64_tr_b16 v[130:131], v52 offset:2560
    v_mfma_f32_32x32x16_bf16 v[100:115], v[132:135], v[144:147], v[100:115]
    s_add_u32 s66, s66, 64
    s_and_b32 s66, s66, 1023
    s_add_u32 m0, s68, 49152
    s_mul_i32 s67, s66, 1536
    buffer_load_dwordx4 v8, s[32:35], s66 offen offset:3072 lds
    ds_read_b128 v[132:135], v50 offset:0
    ds_read_b64_tr_b16 v[140:141], v51 offset:9216
    ds_read_b64_tr_b16 v[142:143], v51 offset:9728
    buffer_load_dwordx4 v9, s[36:39], s67 offen offset:0 lds
    s_waitcnt lgkmcnt(7)
    v_mfma_f32_32x32x16_bf16 v[84:99], v[124:127], v[116:119], v[84:99]
    ds_read_b64_tr_b16 v[136:137], v51 offset:8192
    ds_read_b64_tr_b16 v[138:139], v51 offset:8704
    buffer_load_dwordx4 v9, s[36:39], s67 offen offset:1024 lds
    s_waitcnt lgkmcnt(7)
    v_mfma_f32_32x32x16_bf16 v[68:83], v[120:123], v[116:119], v[68:83]
    ds_read_b64_tr_b16 v[144:145], v52 offset:10240
    ds_read_b64_tr_b16 v[146:147], v52 offset:10752
    buffer_load_dwordx4 v9, s[36:39], s67 offen offset:2048 lds
    s_waitcnt lgkmcnt(7)
    v_mfma_f32_32x32x16_bf16 v[100:115], v[116:119], v[128:131], v[100:115]
    s_waitcnt vmcnt(16) lgkmcnt(0)
    s_barrier
    v_mfma_f32_32x32x16_bf16 v[84:99], v[140:143], v[132:135], v[84:99]
    ds_read_b128 v[116:119], v49 offset:16384
    ds_read_b64_tr_b16 v[124:125], v51 offset:17408
    ds_read_b64_tr_b16 v[126:127], v51 offset:17920
    v_mfma_f32_32x32x16_bf16 v[68:83], v[136:139], v[132:135], v[68:83]
    ds_read_b64_tr_b16 v[120:121], v51 offset:16384
    ds_read_b64_tr_b16 v[122:123], v51 offset:16896
    ds_read_b64_tr_b16 v[128:129], v52 offset:18432
    ds_read_b64_tr_b16 v[130:131], v52 offset:18944
    v_mfma_f32_32x32x16_bf16 v[100:115], v[132:135], v[144:147], v[100:115]
    ds_read_b128 v[132:135], v50 offset:16384
    ds_read_b64_tr_b16 v[140:141], v51 offset:25600
    ds_read_b64_tr_b16 v[142:143], v51 offset:26112
    s_waitcnt lgkmcnt(7)
    v_mfma_f32_32x32x16_bf16 v[84:99], v[124:127], v[116:119], v[84:99]
    ds_read_b64_tr_b16 v[136:137], v51 offset:24576
    ds_read_b64_tr_b16 v[138:139], v51 offset:25088
    s_waitcnt lgkmcnt(7)
    v_mfma_f32_32x32x16_bf16 v[68:83], v[120:123], v[116:119], v[68:83]
    ds_read_b64_tr_b16 v[144:145], v52 offset:26624
    ds_read_b64_tr_b16 v[146:147], v52 offset:27136
    s_waitcnt lgkmcnt(7)
    v_mfma_f32_32x32x16_bf16 v[100:115], v[116:119], v[128:131], v[100:115]
    s_waitcnt vmcnt(12) lgkmcnt(0)
    s_barrier
    v_mfma_f32_32x32x16_bf16 v[84:99], v[140:143], v[132:135], v[84:99]
    ds_read_b128 v[116:119], v45 offset:0
    ds_read_b64_tr_b16 v[124:125], v47 offset:1024
    ds_read_b64_tr_b16 v[126:127], v47 offset:1536
    v_mfma_f32_32x32x16_bf16 v[68:83], v[136:139], v[132:135], v[68:83]
    ds_read_b64_tr_b16 v[120:121], v47 offset:0
    ds_read_b64_tr_b16 v[122:123], v47 offset:512
    ds_read_b64_tr_b16 v[128:129], v48 offset:2048
    ds_read_b64_tr_b16 v[130:131], v48 offset:2560
    v_mfma_f32_32x32x16_bf16 v[100:115], v[132:135], v[144:147], v[100:115]
    ds_read_b128 v[132:135], v46 offset:0
    ds_read_b64_tr_b16 v[140:141], v47 offset:9216
    ds_read_b64_tr_b16 v[142:143], v47 offset:9728
    s_waitcnt lgkmcnt(7)
    v_mfma_f32_32x32x16_bf16 v[84:99], v[124:127], v[116:119], v[84:99]
    ds_read_b64_tr_b16 v[136:137], v47 offset:8192
    ds_read_b64_tr_b16 v[138:139], v47 offset:8704
    s_waitcnt lgkmcnt(7)
    v_mfma_f32_32x32x16_bf16 v[68:83], v[120:123], v[116:119], v[68:83]
    ds_read_b64_tr_b16 v[144:145], v48 offset:10240
    ds_read_b64_tr_b16 v[146:147], v48 offset:10752
    s_waitcnt lgkmcnt(7)
    v_mfma_f32_32x32x16_bf16 v[100:115], v[116:119], v[128:131], v[100:115]
    s_waitcnt vmcnt(8) lgkmcnt(0)
    s_barrier
    v_mfma_f32_32x32x16_bf16 v[84:99], v[140:143], v[132:135], v[84:99]
    ds_read_b128 v[116:119], v45 offset:16384
    ds_read_b64_tr_b16 v[124:125], v47 offset:17408
    ds_read_b64_tr_b16 v[126:127], v47 offset:17920
    v_mfma_f32_32x32x16_bf16 v[68:83], v[136:139], v[132:135], v[68:83]
    ds_read_b64_tr_b16 v[120:121], v47 offset:16384
    ds_read_b64_tr_b16 v[122:123], v47 offset:16896
    ds_read_b64_tr_b16 v[128:129], v48 offset:18432
    ds_read_b64_tr_b16 v[130:131], v48 offset:18944
    v_mfma_f32_32x32x16_bf16 v[100:115], v[132:135], v[144:147], v[100:115]
    ds_read_b128 v[132:135], v46 offset:16384
    ds_read_b64_tr_b16 v[140:141], v47 offset:25600
    ds_read_b64_tr_b16 v[142:143], v47 offset:26112
    s_waitcnt lgkmcnt(7)
    v_mfma_f32_32x32x16_bf16 v[84:99], v[124:127], v[116:119], v[84:99]
    ds_read_b64_tr_b16 v[136:137], v47 offset:24576
    ds_read_b64_tr_b16 v[138:139], v47 offset:25088
    s_waitcnt lgkmcnt(7)
    v_mfma_f32_32x32x16_bf16 v[68:83], v[120:123], v[116:119], v[68:83]
    ds_read_b64_tr_b16 v[144:145], v48 offset:26624
    ds_read_b64_tr_b16 v[146:147], v48 offset:27136
    s_waitcnt lgkmcnt(7)
    v_mfma_f32_32x32x16_bf16 v[100:115], v[116:119], v[128:131], v[100:115]
    s_lshr_b32 s30, s2, 5
    s_lshl_b32 s30, s30, 5
    v_add_u32 v15, s30, v2
    v_subrev_u32 v4, 32, v2
    v_min_u32 v4, 7, v4
    v_lshlrev_b32 v4, 5, v4
    v_add_u32 v4, s88, v4
    v_cmp_gt_u32 vcc, 32, v2
    s_nop 1
    v_cndmask_b32 v15, v4, v15, vcc
    v_lshlrev_b32 v15, 7, v15
    v_add_u32 v15, 14942208, v15
    buffer_load_dword v14, v15, s[44:47], 0 offen sc1
    s_waitcnt vmcnt(5) lgkmcnt(0)
    s_barrier
    v_mfma_f32_32x32x16_bf16 v[84:99], v[140:143], v[132:135], v[84:99]
    ds_read_b128 v[116:119], v45 offset:32768
    ds_read_b64_tr_b16 v[124:125], v47 offset:33792
    ds_read_b64_tr_b16 v[126:127], v47 offset:34304
    v_mfma_f32_32x32x16_bf16 v[68:83], v[136:139], v[132:135], v[68:83]
    ds_read_b64_tr_b16 v[120:121], v47 offset:32768
    ds_read_b64_tr_b16 v[122:123], v47 offset:33280
    ds_read_b64_tr_b16 v[128:129], v48 offset:34816
    ds_read_b64_tr_b16 v[130:131], v48 offset:35328
    v_mfma_f32_32x32x16_bf16 v[100:115], v[132:135], v[144:147], v[100:115]
    ds_read_b128 v[132:135], v46 offset:32768
    ds_read_b64_tr_b16 v[140:141], v47 offset:41984
    ds_read_b64_tr_b16 v[142:143], v47 offset:42496
    s_waitcnt lgkmcnt(7)
    v_mfma_f32_32x32x16_bf16 v[84:99], v[124:127], v[116:119], v[84:99]
    ds_read_b64_tr_b16 v[136:137], v47 offset:40960
    ds_read_b64_tr_b16 v[138:139], v47 offset:41472
    s_waitcnt lgkmcnt(7)
    v_mfma_f32_32x32x16_bf16 v[68:83], v[120:123], v[116:119], v[68:83]
    ds_read_b64_tr_b16 v[144:145], v48 offset:43008
    ds_read_b64_tr_b16 v[146:147], v48 offset:43520
    s_waitcnt lgkmcnt(7)
    v_mfma_f32_32x32x16_bf16 v[100:115], v[116:119], v[128:131], v[100:115]
    s_waitcnt vmcnt(1) lgkmcnt(0)
    s_barrier
    v_mfma_f32_32x32x16_bf16 v[84:99], v[140:143], v[132:135], v[84:99]
    ds_read_b128 v[116:119], v45 offset:49152
    ds_read_b64_tr_b16 v[124:125], v47 offset:50176
    ds_read_b64_tr_b16 v[126:127], v47 offset:50688
    v_mfma_f32_32x32x16_bf16 v[68:83], v[136:139], v[132:135], v[68:83]
    ds_read_b64_tr_b16 v[120:121], v47 offset:49152
    ds_read_b64_tr_b16 v[122:123], v47 offset:49664
    ds_read_b64_tr_b16 v[128:129], v48 offset:51200
    ds_read_b64_tr_b16 v[130:131], v48 offset:51712
    v_mfma_f32_32x32x16_bf16 v[100:115], v[132:135], v[144:147], v[100:115]
    ds_read_b128 v[132:135], v46 offset:49152
    ds_read_b64_tr_b16 v[140:141], v47 offset:58368
    ds_read_b64_tr_b16 v[142:143], v47 offset:58880
    s_waitcnt lgkmcnt(7)
    v_mfma_f32_32x32x16_bf16 v[84:99], v[124:127], v[116:119], v[84:99]
    ds_read_b64_tr_b16 v[136:137], v47 offset:57344
    ds_read_b64_tr_b16 v[138:139], v47 offset:57856
    s_waitcnt lgkmcnt(7)
    v_mfma_f32_32x32x16_bf16 v[68:83], v[120:123], v[116:119], v[68:83]
    ds_read_b64_tr_b16 v[144:145], v48 offset:59392
    ds_read_b64_tr_b16 v[146:147], v48 offset:59904
    s_waitcnt lgkmcnt(7)
    v_mfma_f32_32x32x16_bf16 v[100:115], v[116:119], v[128:131], v[100:115]
    ds_read_b64_tr_b16 v[148:149], v53 offset:0
    ds_read_b64_tr_b16 v[150:151], v53 offset:128
    ds_read_b64_tr_b16 v[152:153], v53 offset:256
    ds_read_b64_tr_b16 v[154:155], v53 offset:384
    s_waitcnt lgkmcnt(4)
    v_mfma_f32_32x32x16_bf16 v[84:99], v[140:143], v[132:135], v[84:99]
    v_mfma_f32_32x32x16_bf16 v[68:83], v[136:139], v[132:135], v[68:83]
    v_mfma_f32_32x32x16_bf16 v[100:115], v[132:135], v[144:147], v[100:115]
    s_barrier
    v_lshlrev_b32 v8, 4, v2
    s_mul_i32 s14, s64, 21248
    s_add_u32 s14, s14, 32768
    s_lshl_b32 s30, s64, 12
    s_lshl_b32 s31, s63, 11
    s_add_u32 s30, s30, s31
    v_add_u32 v9, s30, v8
    s_lshl_b32 s30, s2, 13
    s_add_u32 s15, s30, 0
    s_add_u32 s16, s30, 12845056
    s_add_u32 s22, s14, s31
    s_getpc_b64 s[18:19]
LF_pc:
    s_add_u32 s18, s18, L2c_gtab-LF_pc
    s_addc_u32 s19, s19, 0
    s_waitcnt vmcnt(0)
    s_mov_b32 s90, 0
LF_x_loop:
    v_cmp_eq_u32 vcc, s93, v14
    s_add_u32 s90, s90, 1
    s_cmp_eq_u64 vcc, -1
    s_cbranch_scc1 LF_x_done
    s_sleep 4
    buffer_load_dword v14, v15, s[44:47], 0 offen sc1
    s_waitcnt vmcnt(0)
    s_cmp_lt_u32 s90, 65536
    s_cbranch_scc1 LF_x_loop
LF_x_done:
    s_add_u32 m0, s22, 17120
    s_nop 0
    buffer_load_dwordx4 v9, s[44:47], s15 offen lds
    buffer_load_dwordx4 v9, s[44:47], s15 offen offset:1024 lds
    s_mul_i32 s30, s63, 3072
    v_add_u32 v4, s30, v8
    global_load_dwordx4 v[20:23], v4, s[18:19]
    global_load_dwordx4 v[24:27], v4, s[18:19] offset:1024
    global_load_dwordx4 v[16:19], v4, s[18:19] offset:2048
    s_mov_b32 s48, s10
    s_and_b32 s49, s11, 0xffff
    s_mov_b32 s50, 524288
    s_mov_b32 s51, 0x20000
    s_mov_b32 s52, s76
    s_and_b32 s53, s77, 0xffff
    s_mov_b32 s54, 2097152
    s_mov_b32 s55, 0x20000
    s_and_b32 s31, s88, 3
    s_lshl_b32 s31, s31, 2
    s_add_u32 s31, s31, s62
    s_lshl_b32 s31, s31, 15
    s_lshl_b32 s30, s89, 7
    s_add_u32 s31, s31, s30
    v_and_b32 v13, 31, v2
    v_lshlrev_b32 v13, 10, v13
    buffer_load_dword v13, v13, s[48:51], s31 offen
    v_mov_b32 v66, 0
    v_add_u32 v4, 16640, v8
    v_lshrrev_b32 v5, 1, v2
    v_mul_u32_u24 v5, 4160, v5
    v_and_b32 v6, 1, v2
    v_lshl_add_u32 v5, v6, 4, v5
    v_add_u32 v5, 4096, v5
    s_cmp_eq_u32 s63, 0
    s_cselect_b64 vcc, -1, 0
    s_cselect_b32 s30, 30, 8
    v_cndmask_b32 v4, v5, v4, vcc
    v_add_u32 v10, s14, v4
    v_cmp_gt_u32 vcc, s30, v2
    s_and_saveexec_b64 s[4:5], vcc
    ds_write_b64 v10, v[66:67]
    ds_write_b64 v10, v[66:67] offset:8
    s_mov_b64 exec, s[4:5]
    v_cvt_pk_bf16_f32 v116, v84, v85
    v_cvt_pk_bf16_f32 v117, v86, v87
    v_cvt_pk_bf16_f32 v118, v88, v89
    v_cvt_pk_bf16_f32 v119, v90, v91
    v_cvt_pk_bf16_f32 v120, v92, v93
    v_cvt_pk_bf16_f32 v121, v94, v95
    v_cvt_pk_bf16_f32 v122, v96, v97
    v_cvt_pk_bf16_f32 v123, v98, v99
    s_waitcnt lgkmcnt(0)
    v_mfma_f32_32x32x16_bf16 v[84:99], v[148:151], v[116:119], 0
    v_mfma_f32_32x32x16_bf16 v[84:99], v[152:155], v[120:123], v[84:99]
    v_cvt_pk_bf16_f32 v132, v68, v69
    v_cvt_pk_bf16_f32 v133, v70, v71
    v_cvt_pk_bf16_f32 v134, v72, v73
    v_cvt_pk_bf16_f32 v135, v74, v75
    v_cvt_pk_bf16_f32 v136, v76, v77
    v_cvt_pk_bf16_f32 v137, v78, v79
    v_cvt_pk_bf16_f32 v138, v80, v81
    v_cvt_pk_bf16_f32 v139, v82, v83
    buffer_store_dwordx4 v[132:135], v57, s[44:47], 0 offen offset:0 sc1
    buffer_store_dwordx4 v[136:139], v57, s[44:47], 0 offen offset:1024 sc1
    v_mov_b32 v5, 0x3f803f80
    v_cvt_pk_bf16_f32 v208, v100, v101
    v_cvt_pk_bf16_f32 v209, v102, v103
    v_cvt_pk_bf16_f32 v210, v104, v105
    v_cvt_pk_bf16_f32 v211, v106, v107
    v_cvt_pk_bf16_f32 v212, v108, v109
    v_cvt_pk_bf16_f32 v213, v110, v111
    v_cvt_pk_bf16_f32 v214, v112, v113
    v_cvt_pk_bf16_f32 v215, v114, v115
    v_cndmask_b32 v216, v5, v208, s[74:75]
    v_cndmask_b32 v224, v208, v5, s[74:75]
    v_cndmask_b32 v217, v5, v209, s[74:75]
    v_cndmask_b32 v225, v209, v5, s[74:75]
    v_cndmask_b32 v218, v5, v210, s[74:75]
    v_cndmask_b32 v226, v210, v5, s[74:75]
    v_cndmask_b32 v219, v5, v211, s[74:75]
    v_cndmask_b32 v227, v211, v5, s[74:75]
    v_cndmask_b32 v220, v5, v212, s[74:75]
    v_cndmask_b32 v228, v212, v5, s[74:75]
    v_cndmask_b32 v221, v5, v213, s[74:75]
    v_cndmask_b32 v229, v213, v5, s[74:75]
    v_cndmask_b32 v222, v5, v214, s[74:75]
    v_cndmask_b32 v230, v214, v5, s[74:75]
    v_cndmask_b32 v223, v5, v215, s[74:75]
    v_cndmask_b32 v231, v215, v5, s[74:75]
    v_max3_f32 v188, v84, v85, v86
    v_min3_f32 v190, v84, v85, v86
    v_max3_f32 v188, v188, v87, v88
    v_min3_f32 v190, v190, v87, v88
    v_max3_f32 v188, v188, v89, v90
    v_min3_f32 v190, v190, v89, v90
    v_max3_f32 v188, v188, v91, v92
    v_min3_f32 v190, v190, v91, v92
    v_max3_f32 v188, v188, v93, v94
    v_min3_f32 v190, v190, v93, v94
    v_max3_f32 v188, v188, v95, v96
    v_min3_f32 v190, v190, v95, v96
    v_max3_f32 v188, v188, v97, v98
    v_min3_f32 v190, v190, v97, v98
    v_max_f32 v188, v188, v99
    v_min_f32 v190, v190, v99
    v_mul_f32 v188, 0xbfb8aa3b, v188
    v_mul_f32 v190, 0x3fb8aa3b, v190
    v_pk_fma_f32 v[156:157], v[84:85], s[72:73], v[188:189] op_sel_hi:[1,1,0]
    v_pk_fma_f32 v[158:159], v[86:87], s[72:73], v[188:189] op_sel_hi:[1,1,0]
    v_pk_fma_f32 v[160:161], v[88:89], s[72:73], v[188:189] op_sel_hi:[1,1,0]
    v_pk_fma_f32 v[162:163], v[90:91], s[72:73], v[188:189] op_sel_hi:[1,1,0]
    v_pk_fma_f32 v[164:165], v[92:93], s[72:73], v[188:189] op_sel_hi:[1,1,0]
    v_pk_fma_f32 v[166:167], v[94:95], s[72:73], v[188:189] op_sel_hi:[1,1,0]
    v_pk_fma_f32 v[168:169], v[96:97], s[72:73], v[188:189] op_sel_hi:[1,1,0]
    v_pk_fma_f32 v[170:171], v[98:99], s[72:73], v[188:189] op_sel_hi:[1,1,0]
    v_exp_f32 v172, v156
    v_exp_f32 v173, v157
    v_exp_f32 v174, v158
    v_exp_f32 v175, v159
    v_exp_f32 v176, v160
    v_exp_f32 v177, v161
    v_exp_f32 v178, v162
    v_exp_f32 v179, v163
    v_exp_f32 v180, v164
    v_exp_f32 v181, v165
    v_exp_f32 v182, v166
    v_exp_f32 v183, v167
    v_exp_f32 v184, v168
    v_exp_f32 v185, v169
    v_exp_f32 v186, v170
    v_exp_f32 v187, v171
    v_pk_add_f32 v[156:157], v[172:173], v[174:175]
    v_pk_add_f32 v[158:159], v[176:177], v[178:179]
    v_pk_add_f32 v[160:161], v[180:181], v[182:183]
    v_pk_add_f32 v[162:163], v[184:185], v[186:187]
    v_pk_add_f32 v[156:157], v[156:157], v[158:159]
    v_pk_add_f32 v[160:161], v[160:161], v[162:163]
    v_pk_add_f32 v[156:157], v[156:157], v[160:161]
    v_add_f32 v156, v156, v157
    v_rcp_f32 v156, v156
    s_nop 0
    v_pk_mul_f32 v[172:173], v[172:173], v[156:157] op_sel_hi:[1,0]
    v_pk_mul_f32 v[174:175], v[174:175], v[156:157] op_sel_hi:[1,0]
    v_pk_mul_f32 v[176:177], v[176:177], v[156:157] op_sel_hi:[1,0]
    v_pk_mul_f32 v[178:179], v[178:179], v[156:157] op_sel_hi:[1,0]
    v_pk_mul_f32 v[180:181], v[180:181], v[156:157] op_sel_hi:[1,0]
    v_pk_mul_f32 v[182:183], v[182:183], v[156:157] op_sel_hi:[1,0]
    v_pk_mul_f32 v[184:185], v[184:185], v[156:157] op_sel_hi:[1,0]
    v_pk_mul_f32 v[186:187], v[186:187], v[156:157] op_sel_hi:[1,0]
    v_cvt_pk_bf16_f32 v192, v172, v173
    v_cvt_pk_bf16_f32 v193, v174, v175
    v_cvt_pk_bf16_f32 v196, v176, v177
    v_cvt_pk_bf16_f32 v197, v178, v179
    v_cvt_pk_bf16_f32 v194, v180, v181
    v_cvt_pk_bf16_f32 v195, v182, v183
    v_cvt_pk_bf16_f32 v198, v184, v185
    v_cvt_pk_bf16_f32 v199, v186, v187
    v_pk_fma_f32 v[156:157], v[84:85], s[72:73], v[190:191] op_sel_hi:[1,1,0] neg_lo:[1,0,0] neg_hi:[1,0,0]
    v_pk_fma_f32 v[158:159], v[86:87], s[72:73], v[190:191] op_sel_hi:[1,1,0] neg_lo:[1,0,0] neg_hi:[1,0,0]
    v_pk_fma_f32 v[160:161], v[88:89], s[72:73], v[190:191] op_sel_hi:[1,1,0] neg_lo:[1,0,0] neg_hi:[1,0,0]
    v_pk_fma_f32 v[162:163], v[90:91], s[72:73], v[190:191] op_sel_hi:[1,1,0] neg_lo:[1,0,0] neg_hi:[1,0,0]
    v_pk_fma_f32 v[164:165], v[92:93], s[72:73], v[190:191] op_sel_hi:[1,1,0] neg_lo:[1,0,0] neg_hi:[1,0,0]
    v_pk_fma_f32 v[166:167], v[94:95], s[72:73], v[190:191] op_sel_hi:[1,1,0] neg_lo:[1,0,0] neg_hi:[1,0,0]
    v_pk_fma_f32 v[168:169], v[96:97], s[72:73], v[190:191] op_sel_hi:[1,1,0] neg_lo:[1,0,0] neg_hi:[1,0,0]
    v_pk_fma_f32 v[170:171], v[98:99], s[72:73], v[190:191] op_sel_hi:[1,1,0] neg_lo:[1,0,0] neg_hi:[1,0,0]
    v_exp_f32 v172, v156
    v_exp_f32 v173, v157
    v_exp_f32 v174, v158
    v_exp_f32 v175, v159
    v_exp_f32 v176, v160
    v_exp_f32 v177, v161
    v_exp_f32 v178, v162
    v_exp_f32 v179, v163
    v_exp_f32 v180, v164
    v_exp_f32 v181, v165
    v_exp_f32 v182, v166
    v_exp_f32 v183, v167
    v_exp_f32 v184, v168
    v_exp_f32 v185, v169
    v_exp_f32 v186, v170
    v_exp_f32 v187, v171
    v_pk_add_f32 v[156:157], v[172:173], v[174:175]
    v_pk_add_f32 v[158:159], v[176:177], v[178:179]
    v_pk_add_f32 v[160:161], v[180:181], v[182:183]
    v_pk_add_f32 v[162:163], v[184:185], v[186:187]
    v_pk_add_f32 v[156:157], v[156:157], v[158:159]
    v_pk_add_f32 v[160:161], v[160:161], v[162:163]
    v_pk_add_f32 v[156:157], v[156:157], v[160:161]
    v_add_f32 v156, v156, v157
    v_rcp_f32 v156, v156
    s_nop 0
    v_pk_mul_f32 v[172:173], v[172:173], v[156:157] op_sel_hi:[1,0]
    v_pk_mul_f32 v[174:175], v[174:175], v[156:157] op_sel_hi:[1,0]
    v_pk_mul_f32 v[176:177], v[176:177], v[156:157] op_sel_hi:[1,0]
    v_pk_mul_f32 v[178:179], v[178:179], v[156:157] op_sel_hi:[1,0]
    v_pk_mul_f32 v[180:181], v[180:181], v[156:157] op_sel_hi:[1,0]
    v_pk_mul_f32 v[182:183], v[182:183], v[156:157] op_sel_hi:[1,0]
    v_pk_mul_f32 v[184:185], v[184:185], v[156:157] op_sel_hi:[1,0]
    v_pk_mul_f32 v[186:187], v[186:187], v[156:157] op_sel_hi:[1,0]
    v_cvt_pk_bf16_f32 v200, v172, v173
    v_cvt_pk_bf16_f32 v201, v174, v175
    v_cvt_pk_bf16_f32 v204, v176, v177
    v_cvt_pk_bf16_f32 v205, v178, v179
    v_cvt_pk_bf16_f32 v202, v180, v181
    v_cvt_pk_bf16_f32 v203, v182, v183
    v_cvt_pk_bf16_f32 v206, v184, v185
    v_cvt_pk_bf16_f32 v207, v186, v187
    ds_write_b128 v54, v[192:195]
    v_xor_b32 v4, 16, v54
    ds_write_b128 v4, v[196:199]
    v_xor_b32 v4, 32, v54
    ds_write_b128 v4, v[200:203]
    v_xor_b32 v4, 48, v54
    ds_write_b128 v4, v[204:207]
    ds_read_b64_tr_b16 v[124:125], v56 offset:0
    ds_read_b64_tr_b16 v[126:127], v56 offset:512
    ds_read_b64_tr_b16 v[128:129], v56 offset:1024
    ds_read_b64_tr_b16 v[130:131], v56 offset:1536
    ds_read_b64_tr_b16 v[116:117], v55 offset:0
    ds_read_b64_tr_b16 v[118:119], v55 offset:512
    ds_read_b64_tr_b16 v[120:121], v55 offset:1024
    ds_read_b64_tr_b16 v[122:123], v55 offset:1536
    s_waitcnt lgkmcnt(4)
    v_mfma_f32_32x32x16_bf16 v[84:99], v[124:127], v[224:227], 0
    v_mfma_f32_32x32x16_bf16 v[84:99], v[128:131], v[228:231], v[84:99]
    s_waitcnt lgkmcnt(0)
    v_mfma_f32_32x32x16_bf16 v[68:83], v[116:119], v[216:219], 0
    v_mfma_f32_32x32x16_bf16 v[68:83], v[120:123], v[220:223], v[68:83]
    v_cmp_ge_u32 vcc, 16, v64
    s_nop 7
    ds_write_b128 v58, v[84:87] offset:16384
    ds_write_b128 v58, v[88:91] offset:17408
    ds_write_b128 v58, v[92:95] offset:18432
    ds_write_b128 v58, v[96:99] offset:19456
    s_waitcnt lgkmcnt(0)
    s_barrier
    ds_read_b128 v[156:159], v59 offset:16384
    ds_read_b128 v[160:163], v59 offset:17408
    ds_read_b128 v[164:167], v59 offset:18432
    ds_read_b128 v[168:171], v59 offset:19456
    s_waitcnt lgkmcnt(3)
    v_pk_add_f32 v[68:69], v[68:69], v[156:157]
    v_pk_add_f32 v[70:71], v[70:71], v[158:159]
    s_waitcnt lgkmcnt(2)
    v_pk_add_f32 v[72:73], v[72:73], v[160:161]
    v_pk_add_f32 v[74:75], v[74:75], v[162:163]
    s_waitcnt lgkmcnt(1)
    v_pk_add_f32 v[76:77], v[76:77], v[164:165]
    v_pk_add_f32 v[78:79], v[78:79], v[166:167]
    s_waitcnt lgkmcnt(0)
    v_pk_add_f32 v[80:81], v[80:81], v[168:169]
    v_pk_add_f32 v[82:83], v[82:83], v[170:171]
    v_cvt_pk_bf16_f32 v156, v68, v69
    v_cvt_pk_bf16_f32 v157, v70, v71
    v_cvt_pk_bf16_f32 v158, v72, v73
    v_cvt_pk_bf16_f32 v159, v74, v75
    v_cvt_pk_bf16_f32 v160, v76, v77
    v_cvt_pk_bf16_f32 v161, v78, v79
    v_cvt_pk_bf16_f32 v162, v80, v81
    v_cvt_pk_bf16_f32 v163, v82, v83
    s_and_saveexec_b64 s[4:5], vcc
    buffer_store_dwordx4 v[156:159], v60, s[44:47], 0 offen sc1
    buffer_store_dwordx4 v[160:163], v61, s[44:47], 0 offen sc1
    s_mov_b64 exec, s[4:5]
    v_and_b32 v28, 15, v2
    v_lshrrev_b32 v29, 4, v2
    s_mul_i32 s30, s64, 3200
    s_add_u32 s30, s30, 129536
    v_mov_b32 v34, s30
    s_lshl_b32 s31, s63, 10
    s_add_u32 s31, s31, s14
    v_add_u32 v30, s31, v8
    s_waitcnt vmcnt(5)
    v_add_u32_sdwa v68, v20, v34 dst_sel:DWORD dst_unused:UNUSED_PAD src0_sel:WORD_0 src1_sel:DWORD
    v_add_u32_sdwa v69, v20, v34 dst_sel:DWORD dst_unused:UNUSED_PAD src0_sel:WORD_1 src1_sel:DWORD
    v_add_u32_sdwa v70, v21, v34 dst_sel:DWORD dst_unused:UNUSED_PAD src0_sel:WORD_0 src1_sel:DWORD
    v_add_u32_sdwa v71, v21, v34 dst_sel:DWORD dst_unused:UNUSED_PAD src0_sel:WORD_1 src1_sel:DWORD
    v_add_u32_sdwa v72, v22, v34 dst_sel:DWORD dst_unused:UNUSED_PAD src0_sel:WORD_0 src1_sel:DWORD
    v_add_u32_sdwa v73, v22, v34 dst_sel:DWORD dst_unused:UNUSED_PAD src0_sel:WORD_1 src1_sel:DWORD
    v_add_u32_sdwa v74, v23, v34 dst_sel:DWORD dst_unused:UNUSED_PAD src0_sel:WORD_0 src1_sel:DWORD
    v_add_u32_sdwa v75, v23, v34 dst_sel:DWORD dst_unused:UNUSED_PAD src0_sel:WORD_1 src1_sel:DWORD
    v_add_u32_sdwa v76, v24, v34 dst_sel:DWORD dst_unused:UNUSED_PAD src0_sel:WORD_0 src1_sel:DWORD
    v_add_u32_sdwa v77, v24, v34 dst_sel:DWORD dst_unused:UNUSED_PAD src0_sel:WORD_1 src1_sel:DWORD
    v_add_u32_sdwa v78, v25, v34 dst_sel:DWORD dst_unused:UNUSED_PAD src0_sel:WORD_0 src1_sel:DWORD
    v_add_u32_sdwa v79, v25, v34 dst_sel:DWORD dst_unused:UNUSED_PAD src0_sel:WORD_1 src1_sel:DWORD
    v_add_u32_sdwa v80, v26, v34 dst_sel:DWORD dst_unused:UNUSED_PAD src0_sel:WORD_0 src1_sel:DWORD
    v_add_u32_sdwa v81, v26, v34 dst_sel:DWORD dst_unused:UNUSED_PAD src0_sel:WORD_1 src1_sel:DWORD
    v_add_u32_sdwa v82, v27, v34 dst_sel:DWORD dst_unused:UNUSED_PAD src0_sel:WORD_0 src1_sel:DWORD
    v_add_u32_sdwa v83, v27, v34 dst_sel:DWORD dst_unused:UNUSED_PAD src0_sel:WORD_1 src1_sel:DWORD
    v_add_u32_sdwa v84, v16, v34 dst_sel:DWORD dst_unused:UNUSED_PAD src0_sel:WORD_0 src1_sel:DWORD
    v_add_u32_sdwa v85, v16, v34 dst_sel:DWORD dst_unused:UNUSED_PAD src0_sel:WORD_1 src1_sel:DWORD
    v_add_u32_sdwa v86, v17, v34 dst_sel:DWORD dst_unused:UNUSED_PAD src0_sel:WORD_0 src1_sel:DWORD
    v_add_u32_sdwa v87, v17, v34 dst_sel:DWORD dst_unused:UNUSED_PAD src0_sel:WORD_1 src1_sel:DWORD
    v_add_u32_sdwa v88, v18, v34 dst_sel:DWORD dst_unused:UNUSED_PAD src0_sel:WORD_0 src1_sel:DWORD
    v_add_u32_sdwa v89, v18, v34 dst_sel:DWORD dst_unused:UNUSED_PAD src0_sel:WORD_1 src1_sel:DWORD
    ds_read_b32 v92, v68
    ds_read_b32 v93, v69
    ds_read_b32 v94, v70
    ds_read_b32 v95, v71
    ds_read_b32 v96, v72
    ds_read_b32 v97, v73
    ds_read_b32 v98, v74
    ds_read_b32 v99, v75
    ds_read_b32 v100, v76
    ds_read_b32 v101, v77
    ds_read_b32 v102, v78
    ds_read_b32 v104, v79
    ds_read_b32 v105, v80
    ds_read_b32 v106, v81
    ds_read_b32 v107, v82
    ds_read_b32 v108, v83
    ds_read_b32 v109, v84
    ds_read_b32 v110, v85
    ds_read_b32 v111, v86
    ds_read_b32 v112, v87
    ds_read_b32 v113, v88
    ds_read_b32 v114, v89
    v_and_b32 v4, 3, v28
    v_sub_u32 v4, 3, v4
    v_mul_u32_u24 v4, 4160, v4
    v_lshrrev_b32 v5, 2, v28
    v_lshlrev_b32 v5, 3, v5
    v_sub_u32 v4, v4, v5
    v_lshl_add_u32 v4, v29, 4, v4
    s_lshl_b32 s30, s63, 8
    s_sub_u32 s31, s14, s30
    s_add_u32 s30, s31, 280
    v_add_u32 v31, s30, v4
    v_lshlrev_b32 v4, 5, v28
    v_lshl_add_u32 v5, v29, 4, v4
    s_add_u32 s30, s31, 16896
    v_add_u32 v32, s30, v5
    s_waitcnt lgkmcnt(11)
    v_cvt_pk_bf16_f32 v116, v92, v93
    v_cvt_pk_bf16_f32 v117, v94, v95
    v_cvt_pk_bf16_f32 v118, v96, v97
    v_cvt_pk_bf16_f32 v119, v98, v99
    v_cvt_pk_bf16_f32 v120, v94, v95
    v_cvt_pk_bf16_f32 v121, v96, v97
    v_cvt_pk_bf16_f32 v122, v98, v99
    v_cvt_pk_bf16_f32 v123, v100, v101
    v_cvt_pk_bf16_f32 v132, v102, v102
    v_alignbyte_b32 v124, v120, v116, 2
    v_alignbyte_b32 v125, v121, v117, 2
    v_alignbyte_b32 v126, v122, v118, 2
    v_alignbyte_b32 v127, v123, v119, 2
    v_alignbyte_b32 v128, v121, v120, 2
    v_alignbyte_b32 v129, v122, v121, 2
    v_alignbyte_b32 v130, v123, v122, 2
    v_alignbyte_b32 v131, v132, v123, 2
    ds_write_b128 v30, v[116:119] offset:0
    ds_write_b128 v30, v[124:127] offset:4160
    ds_write_b128 v30, v[120:123] offset:8320
    ds_write_b128 v30, v[128:131] offset:12480
    s_waitcnt lgkmcnt(4)
    v_cvt_pk_bf16_f32 v116, v104, v105
    v_cvt_pk_bf16_f32 v117, v106, v107
    v_cvt_pk_bf16_f32 v118, v108, v109
    v_cvt_pk_bf16_f32 v119, v110, v111
    v_cvt_pk_bf16_f32 v120, v106, v107
    v_cvt_pk_bf16_f32 v121, v108, v109
    v_cvt_pk_bf16_f32 v122, v110, v111
    v_cvt_pk_bf16_f32 v123, v112, v113
    v_cvt_pk_bf16_f32 v132, v114, v114
    v_alignbyte_b32 v124, v120, v116, 2
    v_alignbyte_b32 v125, v121, v117, 2
    v_alignbyte_b32 v126, v122, v118, 2
    v_alignbyte_b32 v127, v123, v119, 2
    v_alignbyte_b32 v128, v121, v120, 2
    v_alignbyte_b32 v129, v122, v121, 2
    v_alignbyte_b32 v130, v123, v122, 2
    v_alignbyte_b32 v131, v132, v123, 2
    ds_write_b128 v30, v[116:119] offset:2048
    ds_write_b128 v30, v[124:127] offset:6208
    ds_write_b128 v30, v[120:123] offset:10368
    ds_write_b128 v30, v[128:131] offset:14528
    s_and_b32 s17, s2, 31
    s_lshr_b32 s20, s2, 5
    s_lshl_b32 s68, s62, 10
    v_mul_u32_u24 v5, 1088, v29
    v_lshl_add_u32 v38, v28, 4, v5
    s_lshl_b32 s30, s62, 8
    v_add_u32 v38, s30, v38
    v_lshrrev_b32 v6, 2, v28
    v_mul_u32_u24 v6, 4352, v6
    v_add_u32 v5, v5, v6
    v_and_b32 v6, 3, v2
    v_lshl_add_u32 v39, v6, 4, v5
    s_mul_i32 s24, s17, 34816
    s_add_u32 s24, s24, 4325376
    s_lshl_b32 s30, s20, 2
    s_add_u32 s30, s30, s62
    s_lshl_b32 s25, s30, 16
    s_lshl_b32 s31, s17, 11
    s_add_u32 s25, s25, s31
    s_add_u32 s25, s25, 6553600
    s_lshl_b32 s26, s30, 16
    s_lshl_b32 s31, s17, 10
    s_add_u32 s26, s26, s31
    s_add_u32 s26, s26, 10747904
    v_and_b32 v4, 31, v2
    v_lshlrev_b32 v49, 7, v4
    s_lshr_b32 s92, s17, 2
    s_lshl_b32 s92, s92, 12
    s_add_u32 s92, s92, 14974976
    s_lshl_b32 s66, s89, 16
    s_lshl_b32 s67, s89, 12
    v_lshrrev_b32 v4, 2, v2
    v_and_b32 v4, 4, v4
    v_xor_b32 v4, v4, v2
    v_and_b32 v4, 7, v4
    v_lshlrev_b32 v4, 4, v4
    v_lshrrev_b32 v7, 3, v2
    s_lshl_b32 s30, s62, 3
    v_add_u32 v5, s30, v7
    v_lshl_add_u32 v4, v5, 10, v4
    s_lshl_b32 s30, s89, 7
    v_add_u32 v50, s30, v4
    s_xor_b32 s30, s62, 1
    s_lshl_b32 s30, s30, 12
    s_add_u32 s30, s30, 147456
    v_add_u32 v35, s30, v8
    s_lshl_b32 s30, s62, 12
    s_add_u32 s30, s30, 147456
    v_add_u32 v36, s30, v8
    v_lshlrev_b32 v4, 5, v28
    v_lshl_add_u32 v4, v29, 3, v4
    v_add_u32 v37, s30, v4
    v_and_b32 v4, 31, v2
    v_lshlrev_b32 v5, 5, v4
    v_lshl_add_u32 v5, v33, 9, v5
    v_lshlrev_b32 v6, 5, v33
    v_add_u32 v6, 2048, v6
    v_cmp_gt_u32 vcc, 16, v4
    s_nop 1
    v_cndmask_b32 v40, v6, v5, vcc
    v_add_u32 v40, 0, v40
    v_mov_b32 v5, 64
    v_mov_b32 v6, 1024
    v_cmp_gt_u32 vcc, 16, v4
    s_nop 1
    v_cndmask_b32 v5, v5, v6, vcc
    v_add_u32 v41, v40, v5
    v_lshlrev_b32 v4, 5, v28
    v_and_b32 v5, 1, v29
    v_lshl_add_u32 v4, v5, 4, v4
    v_add_u32 v43, 2048, v4
    s_lshl_b32 s31, s62, 9
    s_add_u32 s31, s31, 0
    v_add_u32 v42, s31, v4
    v_and_b32 v4, 7, v2
    v_and_b32 v5, 1, v2
    v_lshlrev_b32 v5, 4, v5
    v_mov_b32 v6, 0x3f80
    v_lshlrev_b32 v6, v5, v6
    v_lshrrev_b32 v4, 1, v4
    v_cmp_eq_u32 vcc, 0, v4
    s_nop 1
    v_cndmask_b32 v44, 0, v6, vcc
    v_cmp_eq_u32 vcc, 1, v4
    s_nop 1
    v_cndmask_b32 v45, 0, v6, vcc
    v_cmp_eq_u32 vcc, 2, v4
    s_nop 1
    v_cndmask_b32 v46, 0, v6, vcc
    v_cmp_eq_u32 vcc, 3, v4
    s_nop 1
    v_cndmask_b32 v47, 0, v6, vcc
    v_bfe_u32 v4, v2, 2, 2
    v_lshlrev_b32 v4, 5, v4
    v_and_b32 v5, 1, v29
    v_lshl_add_u32 v4, v5, 4, v4
    v_bfe_u32 v5, v2, 1, 1
    v_lshl_add_u32 v4, v5, 3, v4
    s_add_u32 s30, s68, 4096
    v_add_u32 v4, s30, v4
    v_and_b32 v5, 1, v2
    v_mov_b32 v6, 8192
    v_cmp_eq_u32 vcc, v5, v33
    s_nop 1
    v_cndmask_b32 v48, v6, v4, vcc
    v_mov_b32 v22, 0
    v_mov_b32 v23, 0
    v_lshlrev_b32 v4, 3, v2
    v_add_u32 v4, 8192, v4
    ds_write_b64 v4, v[22:23]
    s_waitcnt vmcnt(0) lgkmcnt(0)
    s_barrier
    s_cmp_eq_u32 s62, 0
    s_cbranch_scc0 LF_sig_k
    s_mov_b64 exec, 1
    v_mov_b32 v6, s93
    v_mov_b32 v7, 0
    buffer_store_dword v6, v7, s[44:47], s85 offen sc1
    s_mov_b64 exec, -1
LF_sig_k:
    ds_read_b128 v[164:167], v32 offset:192
    ds_read_b64 v[100:101], v31 offset:3776
    ds_read_b64 v[102:103], v31 offset:3784
    ds_read_b128 v[168:171], v32 offset:704
    ds_read_b64 v[104:105], v31 offset:3264
    ds_read_b64 v[106:107], v31 offset:3272
    ds_read_b128 v[172:175], v32 offset:1216
    ds_read_b64 v[108:109], v31 offset:2752
    ds_read_b64 v[110:111], v31 offset:2760
    ds_read_b128 v[176:179], v32 offset:1728
    ds_read_b64 v[112:113], v31 offset:2240
    ds_read_b64 v[114:115], v31 offset:2248
    ds_read_b128 v[180:183], v32 offset:2240
    ds_read_b64 v[116:117], v31 offset:1728
    ds_read_b64 v[118:119], v31 offset:1736
    ds_read_b128 v[184:187], v32 offset:2752
    ds_read_b64 v[120:121], v31 offset:1216
    ds_read_b64 v[122:123], v31 offset:1224
    ds_read_b128 v[188:191], v32 offset:3264
    ds_read_b64 v[124:125], v31 offset:704
    ds_read_b64 v[126:127], v31 offset:712
    ds_read_b128 v[192:195], v32 offset:3776
    ds_read_b64 v[128:129], v31 offset:192
    ds_read_b64 v[130:131], v31 offset:200
    s_waitcnt lgkmcnt(15)
    v_mfma_f32_16x16x32_bf16 v[68:71], v[100:103], v[164:167], 0
    s_waitcnt lgkmcnt(15)
    v_mfma_f32_16x16x32_bf16 v[72:75], v[100:103], v[168:171], 0
    v_mfma_f32_16x16x32_bf16 v[72:75], v[104:107], v[164:167], v[72:75]
    v_mfma_f32_16x16x32_bf16 v[76:79], v[104:107], v[168:171], 0
    s_waitcnt lgkmcnt(15)
    v_mfma_f32_16x16x32_bf16 v[76:79], v[100:103], v[172:175], v[76:79]
    v_mfma_f32_16x16x32_bf16 v[76:79], v[108:111], v[164:167], v[76:79]
    v_mfma_f32_16x16x32_bf16 v[80:83], v[104:107], v[172:175], 0
    v_mfma_f32_16x16x32_bf16 v[80:83], v[108:111], v[168:171], v[80:83]
    v_mfma_f32_16x16x32_bf16 v[84:87], v[108:111], v[172:175], 0
    s_waitcnt lgkmcnt(12)
    v_mfma_f32_16x16x32_bf16 v[80:83], v[100:103], v[176:179], v[80:83]
    v_mfma_f32_16x16x32_bf16 v[80:83], v[112:115], v[164:167], v[80:83]
    v_mfma_f32_16x16x32_bf16 v[84:87], v[104:107], v[176:179], v[84:87]
    v_mfma_f32_16x16x32_bf16 v[84:87], v[112:115], v[168:171], v[84:87]
    v_mfma_f32_16x16x32_bf16 v[88:91], v[108:111], v[176:179], 0
    v_mfma_f32_16x16x32_bf16 v[88:91], v[112:115], v[172:175], v[88:91]
    v_mfma_f32_16x16x32_bf16 v[92:95], v[112:115], v[176:179], 0
    s_waitcnt lgkmcnt(9)
    v_mfma_f32_16x16x32_bf16 v[84:87], v[100:103], v[180:183], v[84:87]
    v_mfma_f32_16x16x32_bf16 v[84:87], v[116:119], v[164:167], v[84:87]
    v_mfma_f32_16x16x32_bf16 v[88:91], v[104:107], v[180:183], v[88:91]
    v_mfma_f32_16x16x32_bf16 v[88:91], v[116:119], v[168:171], v[88:91]
    v_mfma_f32_16x16x32_bf16 v[92:95], v[108:111], v[180:183], v[92:95]
    v_mfma_f32_16x16x32_bf16 v[92:95], v[116:119], v[172:175], v[92:95]
    v_mfma_f32_16x16x32_bf16 v[96:99], v[112:115], v[180:183], 0
    v_mfma_f32_16x16x32_bf16 v[96:99], v[116:119], v[176:179], v[96:99]
    s_waitcnt lgkmcnt(6)
    v_mfma_f32_16x16x32_bf16 v[88:91], v[100:103], v[184:187], v[88:91]
    v_mfma_f32_16x16x32_bf16 v[88:91], v[120:123], v[164:167], v[88:91]
    v_mfma_f32_16x16x32_bf16 v[92:95], v[104:107], v[184:187], v[92:95]
    v_mfma_f32_16x16x32_bf16 v[92:95], v[120:123], v[168:171], v[92:95]
    v_mfma_f32_16x16x32_bf16 v[96:99], v[108:111], v[184:187], v[96:99]
    v_mfma_f32_16x16x32_bf16 v[96:99], v[120:123], v[172:175], v[96:99]
    s_waitcnt lgkmcnt(3)
    v_mfma_f32_16x16x32_bf16 v[92:95], v[100:103], v[188:191], v[92:95]
    v_mfma_f32_16x16x32_bf16 v[92:95], v[124:127], v[164:167], v[92:95]
    v_mfma_f32_16x16x32_bf16 v[96:99], v[104:107], v[188:191], v[96:99]
    v_mfma_f32_16x16x32_bf16 v[96:99], v[124:127], v[168:171], v[96:99]
    s_waitcnt lgkmcnt(0)
    ds_read_b128 v[196:199], v32 offset:128
    ds_read_b64 v[132:133], v31 offset:3712
    ds_read_b64 v[134:135], v31 offset:3720
    ds_read_b128 v[200:203], v32 offset:640
    ds_read_b64 v[136:137], v31 offset:3200
    ds_read_b64 v[138:139], v31 offset:3208
    ds_read_b128 v[204:207], v32 offset:1152
    ds_read_b64 v[140:141], v31 offset:2688
    ds_read_b64 v[142:143], v31 offset:2696
    ds_read_b128 v[208:211], v32 offset:1664
    ds_read_b64 v[144:145], v31 offset:2176
    ds_read_b64 v[146:147], v31 offset:2184
    ds_read_b128 v[212:215], v32 offset:2176
    ds_read_b64 v[148:149], v31 offset:1664
    ds_read_b64 v[150:151], v31 offset:1672
    ds_read_b128 v[216:219], v32 offset:2688
    ds_read_b64 v[152:153], v31 offset:1152
    ds_read_b64 v[154:155], v31 offset:1160
    ds_read_b128 v[220:223], v32 offset:3200
    ds_read_b64 v[156:157], v31 offset:640
    ds_read_b64 v[158:159], v31 offset:648
    ds_read_b128 v[224:227], v32 offset:3712
    ds_read_b64 v[160:161], v31 offset:128
    ds_read_b64 v[162:163], v31 offset:136
    v_mfma_f32_16x16x32_bf16 v[96:99], v[100:103], v[192:195], v[96:99]
    v_mfma_f32_16x16x32_bf16 v[96:99], v[128:131], v[164:167], v[96:99]
    s_waitcnt lgkmcnt(0)
    v_mfma_f32_16x16x32_bf16 v[68:71], v[132:135], v[196:199], v[68:71]
    ds_read_b128 v[164:167], v32 offset:64
    v_mfma_f32_16x16x32_bf16 v[72:75], v[132:135], v[200:203], v[72:75]
    ds_read_b64 v[100:101], v31 offset:3648
    v_mfma_f32_16x16x32_bf16 v[72:75], v[136:139], v[196:199], v[72:75]
    ds_read_b64 v[102:103], v31 offset:3656
    v_mfma_f32_16x16x32_bf16 v[76:79], v[136:139], v[200:203], v[76:79]
    ds_read_b128 v[168:171], v32 offset:576
    v_mfma_f32_16x16x32_bf16 v[76:79], v[132:135], v[204:207], v[76:79]
    ds_read_b64 v[104:105], v31 offset:3136
    v_mfma_f32_16x16x32_bf16 v[76:79], v[140:143], v[196:199], v[76:79]
    ds_read_b64 v[106:107], v31 offset:3144
    v_mfma_f32_16x16x32_bf16 v[80:83], v[136:139], v[204:207], v[80:83]
    ds_read_b128 v[172:175], v32 offset:1088
    v_mfma_f32_16x16x32_bf16 v[80:83], v[140:143], v[200:203], v[80:83]
    ds_read_b64 v[108:109], v31 offset:2624
    v_mfma_f32_16x16x32_bf16 v[84:87], v[140:143], v[204:207], v[84:87]
    ds_read_b64 v[110:111], v31 offset:2632
    v_mfma_f32_16x16x32_bf16 v[80:83], v[132:135], v[208:211], v[80:83]
    ds_read_b128 v[176:179], v32 offset:1600
    v_mfma_f32_16x16x32_bf16 v[80:83], v[144:147], v[196:199], v[80:83]
    ds_read_b64 v[112:113], v31 offset:2112
    v_mfma_f32_16x16x32_bf16 v[84:87], v[136:139], v[208:211], v[84:87]
    ds_read_b64 v[114:115], v31 offset:2120
    v_mfma_f32_16x16x32_bf16 v[84:87], v[144:147], v[200:203], v[84:87]
    ds_read_b128 v[180:183], v32 offset:2112
    v_mfma_f32_16x16x32_bf16 v[88:91], v[140:143], v[208:211], v[88:91]
    ds_read_b64 v[116:117], v31 offset:1600
    v_mfma_f32_16x16x32_bf16 v[88:91], v[144:147], v[204:207], v[88:91]
    ds_read_b64 v[118:119], v31 offset:1608
    v_mfma_f32_16x16x32_bf16 v[92:95], v[144:147], v[208:211], v[92:95]
    ds_read_b128 v[184:187], v32 offset:2624
    v_mfma_f32_16x16x32_bf16 v[84:87], v[132:135], v[212:215], v[84:87]
    ds_read_b64 v[120:121], v31 offset:1088
    v_mfma_f32_16x16x32_bf16 v[84:87], v[148:151], v[196:199], v[84:87]
    ds_read_b64 v[122:123], v31 offset:1096
    v_mfma_f32_16x16x32_bf16 v[88:91], v[136:139], v[212:215], v[88:91]
    ds_read_b128 v[188:191], v32 offset:3136
    v_mfma_f32_16x16x32_bf16 v[88:91], v[148:151], v[200:203], v[88:91]
    ds_read_b64 v[124:125], v31 offset:576
    v_mfma_f32_16x16x32_bf16 v[92:95], v[140:143], v[212:215], v[92:95]
    ds_read_b64 v[126:127], v31 offset:584
    v_mfma_f32_16x16x32_bf16 v[92:95], v[148:151], v[204:207], v[92:95]
    ds_read_b128 v[192:195], v32 offset:3648
    v_mfma_f32_16x16x32_bf16 v[96:99], v[144:147], v[212:215], v[96:99]
    ds_read_b64 v[128:129], v31 offset:64
    v_mfma_f32_16x16x32_bf16 v[96:99], v[148:151], v[208:211], v[96:99]
    ds_read_b64 v[130:131], v31 offset:72
    v_mfma_f32_16x16x32_bf16 v[88:91], v[132:135], v[216:219], v[88:91]
    v_mfma_f32_16x16x32_bf16 v[88:91], v[152:155], v[196:199], v[88:91]
    v_mfma_f32_16x16x32_bf16 v[92:95], v[136:139], v[216:219], v[92:95]
    v_mfma_f32_16x16x32_bf16 v[92:95], v[152:155], v[200:203], v[92:95]
    v_mfma_f32_16x16x32_bf16 v[96:99], v[140:143], v[216:219], v[96:99]
    v_mfma_f32_16x16x32_bf16 v[96:99], v[152:155], v[204:207], v[96:99]
    v_mfma_f32_16x16x32_bf16 v[92:95], v[132:135], v[220:223], v[92:95]
    v_mfma_f32_16x16x32_bf16 v[92:95], v[156:159], v[196:199], v[92:95]
    v_mfma_f32_16x16x32_bf16 v[96:99], v[136:139], v[220:223], v[96:99]
    v_mfma_f32_16x16x32_bf16 v[96:99], v[156:159], v[200:203], v[96:99]
    v_mfma_f32_16x16x32_bf16 v[96:99], v[132:135], v[224:227], v[96:99]
    v_mfma_f32_16x16x32_bf16 v[96:99], v[160:163], v[196:199], v[96:99]
    buffer_load_dword v20, v49, s[44:47], s92 offen sc1
    s_waitcnt lgkmcnt(0)
    v_mfma_f32_16x16x32_bf16 v[68:71], v[100:103], v[164:167], v[68:71]
    ds_read_b128 v[196:199], v32 offset:0
    v_mfma_f32_16x16x32_bf16 v[72:75], v[100:103], v[168:171], v[72:75]
    ds_read_b64 v[132:133], v31 offset:3584
    v_mfma_f32_16x16x32_bf16 v[72:75], v[104:107], v[164:167], v[72:75]
    ds_read_b64 v[134:135], v31 offset:3592
    v_mfma_f32_16x16x32_bf16 v[76:79], v[104:107], v[168:171], v[76:79]
    ds_read_b128 v[200:203], v32 offset:512
    v_mfma_f32_16x16x32_bf16 v[76:79], v[100:103], v[172:175], v[76:79]
    ds_read_b64 v[136:137], v31 offset:3072
    v_mfma_f32_16x16x32_bf16 v[76:79], v[108:111], v[164:167], v[76:79]
    ds_read_b64 v[138:139], v31 offset:3080
    v_mfma_f32_16x16x32_bf16 v[80:83], v[104:107], v[172:175], v[80:83]
    ds_read_b128 v[204:207], v32 offset:1024
    v_mfma_f32_16x16x32_bf16 v[80:83], v[108:111], v[168:171], v[80:83]
    ds_read_b64 v[140:141], v31 offset:2560
    v_mfma_f32_16x16x32_bf16 v[84:87], v[108:111], v[172:175], v[84:87]
    ds_read_b64 v[142:143], v31 offset:2568
    v_mfma_f32_16x16x32_bf16 v[80:83], v[100:103], v[176:179], v[80:83]
    ds_read_b128 v[208:211], v32 offset:1536
    v_mfma_f32_16x16x32_bf16 v[80:83], v[112:115], v[164:167], v[80:83]
    ds_read_b64 v[144:145], v31 offset:2048
    v_mfma_f32_16x16x32_bf16 v[84:87], v[104:107], v[176:179], v[84:87]
    ds_read_b64 v[146:147], v31 offset:2056
    v_mfma_f32_16x16x32_bf16 v[84:87], v[112:115], v[168:171], v[84:87]
    ds_read_b128 v[212:215], v32 offset:2048
    v_mfma_f32_16x16x32_bf16 v[88:91], v[108:111], v[176:179], v[88:91]
    ds_read_b64 v[148:149], v31 offset:1536
    v_mfma_f32_16x16x32_bf16 v[88:91], v[112:115], v[172:175], v[88:91]
    ds_read_b64 v[150:151], v31 offset:1544
    v_mfma_f32_16x16x32_bf16 v[92:95], v[112:115], v[176:179], v[92:95]
    ds_read_b128 v[216:219], v32 offset:2560
    v_mfma_f32_16x16x32_bf16 v[84:87], v[100:103], v[180:183], v[84:87]
    ds_read_b64 v[152:153], v31 offset:1024
    v_mfma_f32_16x16x32_bf16 v[84:87], v[116:119], v[164:167], v[84:87]
    ds_read_b64 v[154:155], v31 offset:1032
    v_mfma_f32_16x16x32_bf16 v[88:91], v[104:107], v[180:183], v[88:91]
    ds_read_b128 v[220:223], v32 offset:3072
    v_mfma_f32_16x16x32_bf16 v[88:91], v[116:119], v[168:171], v[88:91]
    ds_read_b64 v[156:157], v31 offset:512
    v_mfma_f32_16x16x32_bf16 v[92:95], v[108:111], v[180:183], v[92:95]
    ds_read_b64 v[158:159], v31 offset:520
    v_mfma_f32_16x16x32_bf16 v[92:95], v[116:119], v[172:175], v[92:95]
    ds_read_b128 v[224:227], v32 offset:3584
    v_mfma_f32_16x16x32_bf16 v[96:99], v[112:115], v[180:183], v[96:99]
    ds_read_b64 v[160:161], v31 offset:0
    v_mfma_f32_16x16x32_bf16 v[96:99], v[116:119], v[176:179], v[96:99]
    s_waitcnt vmcnt(0)
    s_mov_b32 s90, 0
LF_k_loop:
    v_cmp_eq_u32 vcc, s93, v20
    s_add_u32 s90, s90, 1
    s_cmp_eq_u64 vcc, -1
    s_cbranch_scc1 LF_k_done
    s_sleep 4
    buffer_load_dword v20, v49, s[44:47], s92 offen sc1
    s_waitcnt vmcnt(0)
    s_cmp_lt_u32 s90, 65536
    s_cbranch_scc1 LF_k_loop
LF_k_done:
    buffer_load_dwordx4 a[0:3], v8, s[44:47], s25 offen offset:0
    ds_read_b64 v[162:163], v31 offset:8
    v_mfma_f32_16x16x32_bf16 v[88:91], v[100:103], v[184:187], v[88:91]
    v_mfma_f32_16x16x32_bf16 v[88:91], v[120:123], v[164:167], v[88:91]
    v_mfma_f32_16x16x32_bf16 v[92:95], v[104:107], v[184:187], v[92:95]
    v_mfma_f32_16x16x32_bf16 v[92:95], v[120:123], v[168:171], v[92:95]
    buffer_load_dwordx4 a[4:7], v8, s[44:47], s25 offen offset:1024
    v_mfma_f32_16x16x32_bf16 v[96:99], v[108:111], v[184:187], v[96:99]
    v_mfma_f32_16x16x32_bf16 v[96:99], v[120:123], v[172:175], v[96:99]
    v_mfma_f32_16x16x32_bf16 v[92:95], v[100:103], v[188:191], v[92:95]
    v_mfma_f32_16x16x32_bf16 v[92:95], v[124:127], v[164:167], v[92:95]
    s_add_u32 m0, s68, 4096
    s_lshl_b32 s22, s17, 9
    buffer_load_dwordx4 v8, s[40:43], s22 offen lds
    v_mfma_f32_16x16x32_bf16 v[96:99], v[104:107], v[188:191], v[96:99]
    v_mfma_f32_16x16x32_bf16 v[96:99], v[124:127], v[168:171], v[96:99]
    v_mfma_f32_16x16x32_bf16 v[96:99], v[100:103], v[192:195], v[96:99]
    v_mfma_f32_16x16x32_bf16 v[96:99], v[128:131], v[164:167], v[96:99]
    s_add_u32 s22, s24, 0
    buffer_load_dwordx4 a[8:11], v38, s[44:47], s22 offen
    s_waitcnt lgkmcnt(0)
    v_mfma_f32_16x16x32_bf16 v[68:71], v[132:135], v[196:199], v[68:71]
    v_mfma_f32_16x16x32_bf16 v[72:75], v[132:135], v[200:203], v[72:75]
    v_mfma_f32_16x16x32_bf16 v[72:75], v[136:139], v[196:199], v[72:75]
    v_mfma_f32_16x16x32_bf16 v[76:79], v[136:139], v[200:203], v[76:79]
    s_add_u32 s22, s24, 4352
    buffer_load_dwordx4 a[12:15], v38, s[44:47], s22 offen
    v_mfma_f32_16x16x32_bf16 v[76:79], v[132:135], v[204:207], v[76:79]
    v_mfma_f32_16x16x32_bf16 v[76:79], v[140:143], v[196:199], v[76:79]
    v_mfma_f32_16x16x32_bf16 v[80:83], v[136:139], v[204:207], v[80:83]
    v_mfma_f32_16x16x32_bf16 v[80:83], v[140:143], v[200:203], v[80:83]
    s_add_u32 s22, s24, 8704
    buffer_load_dwordx4 a[16:19], v38, s[44:47], s22 offen
    v_mfma_f32_16x16x32_bf16 v[84:87], v[140:143], v[204:207], v[84:87]
    v_mfma_f32_16x16x32_bf16 v[80:83], v[132:135], v[208:211], v[80:83]
    v_mfma_f32_16x16x32_bf16 v[80:83], v[144:147], v[196:199], v[80:83]
    v_mfma_f32_16x16x32_bf16 v[84:87], v[136:139], v[208:211], v[84:87]
    s_add_u32 s22, s24, 13056
    buffer_load_dwordx4 a[20:23], v38, s[44:47], s22 offen
    v_mfma_f32_16x16x32_bf16 v[84:87], v[144:147], v[200:203], v[84:87]
    v_mfma_f32_16x16x32_bf16 v[88:91], v[140:143], v[208:211], v[88:91]
    v_mfma_f32_16x16x32_bf16 v[88:91], v[144:147], v[204:207], v[88:91]
    v_mfma_f32_16x16x32_bf16 v[92:95], v[144:147], v[208:211], v[92:95]
    s_add_u32 s22, s24, 17408
    buffer_load_dwordx4 a[24:27], v38, s[44:47], s22 offen
    v_mfma_f32_16x16x32_bf16 v[84:87], v[132:135], v[212:215], v[84:87]
    v_mfma_f32_16x16x32_bf16 v[84:87], v[148:151], v[196:199], v[84:87]
    v_mfma_f32_16x16x32_bf16 v[88:91], v[136:139], v[212:215], v[88:91]
    v_mfma_f32_16x16x32_bf16 v[88:91], v[148:151], v[200:203], v[88:91]
    s_add_u32 s22, s24, 21760
    buffer_load_dwordx4 a[28:31], v38, s[44:47], s22 offen
    v_mfma_f32_16x16x32_bf16 v[92:95], v[140:143], v[212:215], v[92:95]
    v_mfma_f32_16x16x32_bf16 v[92:95], v[148:151], v[204:207], v[92:95]
    v_mfma_f32_16x16x32_bf16 v[96:99], v[144:147], v[212:215], v[96:99]
    v_mfma_f32_16x16x32_bf16 v[96:99], v[148:151], v[208:211], v[96:99]
    s_add_u32 s22, s24, 26112
    buffer_load_dwordx4 a[32:35], v38, s[44:47], s22 offen
    v_mfma_f32_16x16x32_bf16 v[88:91], v[132:135], v[216:219], v[88:91]
    v_mfma_f32_16x16x32_bf16 v[88:91], v[152:155], v[196:199], v[88:91]
    v_mfma_f32_16x16x32_bf16 v[92:95], v[136:139], v[216:219], v[92:95]
    v_mfma_f32_16x16x32_bf16 v[92:95], v[152:155], v[200:203], v[92:95]
    s_add_u32 s22, s24, 30464
    buffer_load_dwordx4 a[36:39], v38, s[44:47], s22 offen
    v_mfma_f32_16x16x32_bf16 v[96:99], v[140:143], v[216:219], v[96:99]
    v_mfma_f32_16x16x32_bf16 v[96:99], v[152:155], v[204:207], v[96:99]
    v_mfma_f32_16x16x32_bf16 v[92:95], v[132:135], v[220:223], v[92:95]
    v_mfma_f32_16x16x32_bf16 v[92:95], v[156:159], v[196:199], v[92:95]
    s_add_u32 s22, s24, 1024
    buffer_load_dwordx4 a[40:43], v39, s[44:47], s22 offen
    v_mfma_f32_16x16x32_bf16 v[96:99], v[136:139], v[220:223], v[96:99]
    v_mfma_f32_16x16x32_bf16 v[96:99], v[156:159], v[200:203], v[96:99]
    v_mfma_f32_16x16x32_bf16 v[96:99], v[132:135], v[224:227], v[96:99]
    v_mfma_f32_16x16x32_bf16 v[96:99], v[160:163], v[196:199], v[96:99]
    s_add_u32 s22, s24, 18432
    buffer_load_dwordx4 a[44:47], v39, s[44:47], s22 offen
    s_cmp_eq_u32 s63, 0
    s_cbranch_scc1 L_c_noswap
    v_swap_b32 v68, v84
    v_swap_b32 v69, v85
    v_swap_b32 v70, v86
    v_swap_b32 v71, v87
    v_swap_b32 v72, v88
    v_swap_b32 v73, v89
    v_swap_b32 v74, v90
    v_swap_b32 v75, v91
    v_swap_b32 v76, v92
    v_swap_b32 v77, v93
    v_swap_b32 v78, v94
    v_swap_b32 v79, v95
    v_swap_b32 v80, v96
    v_swap_b32 v81, v97
    v_swap_b32 v82, v98
    v_swap_b32 v83, v99
L_c_noswap:
    s_nop 3
    ds_write_b128 v35, v[84:87] offset:0
    ds_write_b128 v35, v[88:91] offset:1024
    ds_write_b128 v35, v[92:95] offset:2048
    ds_write_b128 v35, v[96:99] offset:3072
    s_waitcnt lgkmcnt(0)
    s_barrier
    ds_read_b128 v[164:167], v36 offset:0
    ds_read_b128 v[168:171], v36 offset:1024
    ds_read_b128 v[172:175], v36 offset:2048
    ds_read_b128 v[176:179], v36 offset:3072
    s_waitcnt lgkmcnt(3)
    v_add_f32 v68, v68, v164
    v_add_f32 v69, v69, v165
    v_add_f32 v70, v70, v166
    v_add_f32 v71, v71, v167
    v_cvt_pk_bf16_f32 v100, v68, v69
    v_cvt_pk_bf16_f32 v101, v70, v71
    ds_write_b64 v37, v[100:101] offset:0
    s_waitcnt lgkmcnt(3)
    v_add_f32 v72, v72, v168
    v_add_f32 v73, v73, v169
    v_add_f32 v74, v74, v170
    v_add_f32 v75, v75, v171
    v_cvt_pk_bf16_f32 v102, v72, v73
    v_cvt_pk_bf16_f32 v103, v74, v75
    ds_write_b64 v37, v[102:103] offset:512
    s_waitcnt lgkmcnt(3)
    v_add_f32 v76, v76, v172
    v_add_f32 v77, v77, v173
    v_add_f32 v78, v78, v174
    v_add_f32 v79, v79, v175
    v_cvt_pk_bf16_f32 v104, v76, v77
    v_cvt_pk_bf16_f32 v105, v78, v79
    ds_write_b64 v37, v[104:105] offset:1024
    s_waitcnt lgkmcnt(3)
    v_add_f32 v80, v80, v176
    v_add_f32 v81, v81, v177
    v_add_f32 v82, v82, v178
    v_add_f32 v83, v83, v179
    v_cvt_pk_bf16_f32 v106, v80, v81
    v_cvt_pk_bf16_f32 v107, v82, v83
    ds_write_b64 v37, v[106:107] offset:1536
    ds_read_b128 v[108:111], v36 offset:0
    ds_read_b128 v[112:115], v36 offset:1024
    s_waitcnt lgkmcnt(1)
    buffer_store_dwordx4 v[108:111], v9, s[44:47], s16 offen offset:0 sc1
    s_waitcnt lgkmcnt(0)
    buffer_store_dwordx4 v[112:115], v9, s[44:47], s16 offen offset:1024 sc1
    s_waitcnt vmcnt(12)
    ds_read_b64_tr_b16 v[132:133], v48 offset:0
    ds_read_b64_tr_b16 v[134:135], v48 offset:128
    ds_read_b64_tr_b16 v[136:137], v48 offset:256
    ds_read_b64_tr_b16 v[138:139], v48 offset:384
    s_waitcnt lgkmcnt(0)
    v_mfma_f32_32x32x16_bf16 v[140:155], v[132:135], a[0:3], 0
    v_mfma_f32_32x32x16_bf16 v[140:155], v[136:139], a[4:7], v[140:155]
    s_waitcnt vmcnt(2)
    v_mfma_f32_16x16x32_bf16 v[184:187], v[44:47], a[40:43], 0
    v_mfma_f32_16x16x32_bf16 v[184:187], v[44:47], a[44:47], v[184:187]
    v_mfma_f32_16x16x32_bf16 v[180:183], v[44:47], a[8:11], 0
    v_mfma_f32_16x16x32_bf16 v[180:183], v[44:47], a[12:15], v[180:183]
    v_mfma_f32_16x16x32_bf16 v[180:183], v[44:47], a[16:19], v[180:183]
    v_mfma_f32_16x16x32_bf16 v[180:183], v[44:47], a[20:23], v[180:183]
    v_mfma_f32_16x16x32_bf16 v[180:183], v[44:47], a[24:27], v[180:183]
    v_mfma_f32_16x16x32_bf16 v[180:183], v[44:47], a[28:31], v[180:183]
    v_mfma_f32_16x16x32_bf16 v[180:183], v[44:47], a[32:35], v[180:183]
    v_mfma_f32_16x16x32_bf16 v[180:183], v[44:47], a[36:39], v[180:183]
    v_add_f32_dpp v184, v184, v184 row_ror:4 row_mask:0xf bank_mask:0xf
    v_add_f32_dpp v185, v185, v185 row_ror:4 row_mask:0xf bank_mask:0xf
    v_add_f32_dpp v186, v186, v186 row_ror:4 row_mask:0xf bank_mask:0xf
    v_add_f32_dpp v187, v187, v187 row_ror:4 row_mask:0xf bank_mask:0xf
    v_add_f32_dpp v184, v184, v184 row_ror:8 row_mask:0xf bank_mask:0xf
    v_add_f32_dpp v185, v185, v185 row_ror:8 row_mask:0xf bank_mask:0xf
    v_add_f32_dpp v186, v186, v186 row_ror:8 row_mask:0xf bank_mask:0xf
    v_add_f32_dpp v187, v187, v187 row_ror:8 row_mask:0xf bank_mask:0xf
    v_cmp_gt_u32 vcc, 32, v2
    s_and_saveexec_b64 s[4:5], vcc
    ds_write_b128 v42, v[180:183]
    v_and_b32 v4, 12, v2
    v_cmp_eq_u32 vcc, 0, v4
    s_and_b64 exec, exec, vcc
    ds_write_b128 v43, v[184:187]
    s_mov_b64 exec, s[4:5]
    v_max3_f32 v204, v140, v141, v142
    v_min3_f32 v206, v140, v141, v142
    v_max3_f32 v204, v204, v143, v144
    v_min3_f32 v206, v206, v143, v144
    v_max3_f32 v204, v204, v145, v146
    v_min3_f32 v206, v206, v145, v146
    v_max3_f32 v204, v204, v147, v148
    v_min3_f32 v206, v206, v147, v148
    v_max3_f32 v204, v204, v149, v150
    v_min3_f32 v206, v206, v149, v150
    v_max3_f32 v204, v204, v151, v152
    v_min3_f32 v206, v206, v151, v152
    v_max3_f32 v204, v204, v153, v154
    v_min3_f32 v206, v206, v153, v154
    v_max_f32 v204, v204, v155
    v_min_f32 v206, v206, v155
    v_mul_f32 v204, 0xbfb8aa3b, v204
    v_mul_f32 v206, 0x3fb8aa3b, v206
    v_pk_fma_f32 v[156:157], v[140:141], s[72:73], v[204:205] op_sel_hi:[1,1,0]
    v_pk_fma_f32 v[158:159], v[142:143], s[72:73], v[204:205] op_sel_hi:[1,1,0]
    v_pk_fma_f32 v[160:161], v[144:145], s[72:73], v[204:205] op_sel_hi:[1,1,0]
    v_pk_fma_f32 v[162:163], v[146:147], s[72:73], v[204:205] op_sel_hi:[1,1,0]
    v_pk_fma_f32 v[164:165], v[148:149], s[72:73], v[204:205] op_sel_hi:[1,1,0]
    v_pk_fma_f32 v[166:167], v[150:151], s[72:73], v[204:205] op_sel_hi:[1,1,0]
    v_pk_fma_f32 v[168:169], v[152:153], s[72:73], v[204:205] op_sel_hi:[1,1,0]
    v_pk_fma_f32 v[170:171], v[154:155], s[72:73], v[204:205] op_sel_hi:[1,1,0]
    v_exp_f32 v188, v156
    v_exp_f32 v189, v157
    v_exp_f32 v190, v158
    v_exp_f32 v191, v159
    v_exp_f32 v192, v160
    v_exp_f32 v193, v161
    v_exp_f32 v194, v162
    v_exp_f32 v195, v163
    v_exp_f32 v196, v164
    v_exp_f32 v197, v165
    v_exp_f32 v198, v166
    v_exp_f32 v199, v167
    v_exp_f32 v200, v168
    v_exp_f32 v201, v169
    v_exp_f32 v202, v170
    v_exp_f32 v203, v171
    v_pk_add_f32 v[156:157], v[188:189], v[190:191]
    v_pk_add_f32 v[158:159], v[192:193], v[194:195]
    v_pk_add_f32 v[160:161], v[196:197], v[198:199]
    v_pk_add_f32 v[162:163], v[200:201], v[202:203]
    v_pk_add_f32 v[156:157], v[156:157], v[158:159]
    v_pk_add_f32 v[160:161], v[160:161], v[162:163]
    v_pk_add_f32 v[156:157], v[156:157], v[160:161]
    v_add_f32 v156, v156, v157
    v_rcp_f32 v156, v156
    s_nop 0
    v_pk_mul_f32 v[188:189], v[188:189], v[156:157] op_sel_hi:[1,0]
    v_pk_mul_f32 v[190:191], v[190:191], v[156:157] op_sel_hi:[1,0]
    v_pk_mul_f32 v[192:193], v[192:193], v[156:157] op_sel_hi:[1,0]
    v_pk_mul_f32 v[194:195], v[194:195], v[156:157] op_sel_hi:[1,0]
    v_pk_mul_f32 v[196:197], v[196:197], v[156:157] op_sel_hi:[1,0]
    v_pk_mul_f32 v[198:199], v[198:199], v[156:157] op_sel_hi:[1,0]
    v_pk_mul_f32 v[200:201], v[200:201], v[156:157] op_sel_hi:[1,0]
    v_pk_mul_f32 v[202:203], v[202:203], v[156:157] op_sel_hi:[1,0]
    v_cvt_pk_bf16_f32 v116, v188, v189
    v_cvt_pk_bf16_f32 v117, v190, v191
    v_cvt_pk_bf16_f32 v120, v192, v193
    v_cvt_pk_bf16_f32 v121, v194, v195
    v_cvt_pk_bf16_f32 v118, v196, v197
    v_cvt_pk_bf16_f32 v119, v198, v199
    v_cvt_pk_bf16_f32 v122, v200, v201
    v_cvt_pk_bf16_f32 v123, v202, v203
    v_pk_fma_f32 v[156:157], v[140:141], s[72:73], v[206:207] op_sel_hi:[1,1,0] neg_lo:[1,0,0] neg_hi:[1,0,0]
    v_pk_fma_f32 v[158:159], v[142:143], s[72:73], v[206:207] op_sel_hi:[1,1,0] neg_lo:[1,0,0] neg_hi:[1,0,0]
    v_pk_fma_f32 v[160:161], v[144:145], s[72:73], v[206:207] op_sel_hi:[1,1,0] neg_lo:[1,0,0] neg_hi:[1,0,0]
    v_pk_fma_f32 v[162:163], v[146:147], s[72:73], v[206:207] op_sel_hi:[1,1,0] neg_lo:[1,0,0] neg_hi:[1,0,0]
    v_pk_fma_f32 v[164:165], v[148:149], s[72:73], v[206:207] op_sel_hi:[1,1,0] neg_lo:[1,0,0] neg_hi:[1,0,0]
    v_pk_fma_f32 v[166:167], v[150:151], s[72:73], v[206:207] op_sel_hi:[1,1,0] neg_lo:[1,0,0] neg_hi:[1,0,0]
    v_pk_fma_f32 v[168:169], v[152:153], s[72:73], v[206:207] op_sel_hi:[1,1,0] neg_lo:[1,0,0] neg_hi:[1,0,0]
    v_pk_fma_f32 v[170:171], v[154:155], s[72:73], v[206:207] op_sel_hi:[1,1,0] neg_lo:[1,0,0] neg_hi:[1,0,0]
    v_exp_f32 v188, v156
    v_exp_f32 v189, v157
    v_exp_f32 v190, v158
    v_exp_f32 v191, v159
    v_exp_f32 v192, v160
    v_exp_f32 v193, v161
    v_exp_f32 v194, v162
    v_exp_f32 v195, v163
    v_exp_f32 v196, v164
    v_exp_f32 v197, v165
    v_exp_f32 v198, v166
    v_exp_f32 v199, v167
    v_exp_f32 v200, v168
    v_exp_f32 v201, v169
    v_exp_f32 v202, v170
    v_exp_f32 v203, v171
    v_pk_add_f32 v[156:157], v[188:189], v[190:191]
    v_pk_add_f32 v[158:159], v[192:193], v[194:195]
    v_pk_add_f32 v[160:161], v[196:197], v[198:199]
    v_pk_add_f32 v[162:163], v[200:201], v[202:203]
    v_pk_add_f32 v[156:157], v[156:157], v[158:159]
    v_pk_add_f32 v[160:161], v[160:161], v[162:163]
    v_pk_add_f32 v[156:157], v[156:157], v[160:161]
    v_add_f32 v156, v156, v157
    v_rcp_f32 v156, v156
    s_nop 0
    v_pk_mul_f32 v[188:189], v[188:189], v[156:157] op_sel_hi:[1,0]
    v_pk_mul_f32 v[190:191], v[190:191], v[156:157] op_sel_hi:[1,0]
    v_pk_mul_f32 v[192:193], v[192:193], v[156:157] op_sel_hi:[1,0]
    v_pk_mul_f32 v[194:195], v[194:195], v[156:157] op_sel_hi:[1,0]
    v_pk_mul_f32 v[196:197], v[196:197], v[156:157] op_sel_hi:[1,0]
    v_pk_mul_f32 v[198:199], v[198:199], v[156:157] op_sel_hi:[1,0]
    v_pk_mul_f32 v[200:201], v[200:201], v[156:157] op_sel_hi:[1,0]
    v_pk_mul_f32 v[202:203], v[202:203], v[156:157] op_sel_hi:[1,0]
    v_cvt_pk_bf16_f32 v124, v188, v189
    v_cvt_pk_bf16_f32 v125, v190, v191
    v_cvt_pk_bf16_f32 v128, v192, v193
    v_cvt_pk_bf16_f32 v129, v194, v195
    v_cvt_pk_bf16_f32 v126, v196, v197
    v_cvt_pk_bf16_f32 v127, v198, v199
    v_cvt_pk_bf16_f32 v130, v200, v201
    v_cvt_pk_bf16_f32 v131, v202, v203
    v_permlane32_swap_b32 v116, v120
    v_permlane32_swap_b32 v117, v121
    v_permlane32_swap_b32 v118, v122
    v_permlane32_swap_b32 v119, v123
    v_permlane32_swap_b32 v124, v128
    v_permlane32_swap_b32 v125, v129
    v_permlane32_swap_b32 v126, v130
    v_permlane32_swap_b32 v127, v131
    s_waitcnt vmcnt(0) lgkmcnt(0)
    s_barrier
    s_cmp_eq_u32 s62, 0
    s_cbranch_scc0 LF_sig_b
    s_mov_b64 exec, 1
    v_mov_b32 v6, s93
    v_mov_b32 v7, 0
    buffer_store_dword v6, v7, s[44:47], s87 offen sc1
    s_mov_b64 exec, -1
LF_sig_b:
    ds_read_b128 v[68:71], v40 offset:0
    ds_read_b128 v[72:75], v40 offset:16
    ds_read_b128 v[76:79], v41 offset:0
    ds_read_b128 v[80:83], v41 offset:16
    s_waitcnt lgkmcnt(0)
    v_cvt_pk_bf16_f32 v132, v68, v69
    v_cvt_pk_bf16_f32 v133, v70, v71
    v_cvt_pk_bf16_f32 v134, v72, v73
    v_cvt_pk_bf16_f32 v135, v74, v75
    v_cvt_pk_bf16_f32 v136, v76, v77
    v_cvt_pk_bf16_f32 v137, v78, v79
    v_cvt_pk_bf16_f32 v138, v80, v81
    v_cvt_pk_bf16_f32 v139, v82, v83
    v_mfma_f32_32x32x16_bf16 v[140:155], v[132:135], v[116:119], 0
    s_nop 0
    v_mfma_f32_32x32x16_bf16 v[140:155], v[136:139], v[124:127], v[140:155]
    v_mfma_f32_32x32x16_bf16 v[156:171], v[132:135], v[120:123], 0
    v_mfma_f32_32x32x16_bf16 v[156:171], v[136:139], v[128:131], v[156:171]
    s_nop 9
    v_add_f32 v148, 0x358637bd, v148
    v_rcp_f32 v148, v148
    s_nop 0
    v_mul_f32 v140, v140, v148
    v_mul_f32 v141, v141, v148
    v_mul_f32 v142, v142, v148
    v_mul_f32 v143, v143, v148
    v_mul_f32 v144, v144, v148
    v_mul_f32 v145, v145, v148
    v_mul_f32 v146, v146, v148
    v_mul_f32 v147, v147, v148
    v_cvt_pk_bf16_f32 v172, v140, v141
    v_cvt_pk_bf16_f32 v173, v142, v143
    v_cvt_pk_bf16_f32 v174, v144, v145
    v_cvt_pk_bf16_f32 v175, v146, v147
    s_add_u32 s22, s26, 0
    buffer_store_dwordx4 v[172:175], v8, s[44:47], s22 offen sc1
    v_add_f32 v164, 0x358637bd, v164
    v_rcp_f32 v164, v164
    s_nop 0
    v_mul_f32 v156, v156, v164
    v_mul_f32 v157, v157, v164
    v_mul_f32 v158, v158, v164
    v_mul_f32 v159, v159, v164
    v_mul_f32 v160, v160, v164
    v_mul_f32 v161, v161, v164
    v_mul_f32 v162, v162, v164
    v_mul_f32 v163, v163, v164
    v_cvt_pk_bf16_f32 v176, v156, v157
    v_cvt_pk_bf16_f32 v177, v158, v159
    v_cvt_pk_bf16_f32 v178, v160, v161
    v_cvt_pk_bf16_f32 v179, v162, v163
    s_add_u32 s22, s26, 32768
    buffer_store_dwordx4 v[176:179], v8, s[44:47], s22 offen sc1
    s_lshl_b32 s31, s63, 15
    s_lshl_b32 s21, s64, 10
    s_add_u32 s69, s31, s21
    v_add_u32 v51, s69, v8
    s_add_u32 s69, s69, 0
    s_add_u32 s31, s31, 0
    v_add_u32 v52, s31, v8
    s_lshl_b32 s27, s88, 16
    s_add_u32 s27, s27, 10747904
    v_lshrrev_b32 v7, 3, v2
    s_lshl_b32 s30, s62, 4
    v_add_u32 v5, s30, v7
    v_and_b32 v6, 7, v2
    v_lshlrev_b32 v6, 4, v6
    v_lshl_add_u32 v59, v5, 12, v6
    v_lshl_add_u32 v61, v5, 10, v6
    v_xor_b32 v4, v7, v2
    v_and_b32 v4, 7, v4
    v_lshlrev_b32 v4, 4, v4
    v_lshl_add_u32 v58, v5, 7, v4
    v_add_u32 v58, 81920, v58
    s_lshl_b32 s60, s89, 18
    s_lshl_b32 s30, s88, 7
    s_add_u32 s60, s60, s30
    s_add_u32 s60, s60, 12845056
    s_lshl_b32 s65, s88, 16
    s_lshl_b32 s30, s89, 7
    s_add_u32 s65, s65, s30
    v_and_b32 v4, 31, v2
    s_lshl_b32 s30, s63, 5
    v_add_u32 v4, s30, v4
    v_lshlrev_b32 v5, 2, v4
    v_lshl_add_u32 v60, v33, 15, v5
    s_lshl_b32 s61, s88, 8
    s_add_u32 s61, s61, 4259840
    s_lshl_b32 s30, s64, 2
    v_lshl_add_u32 v5, v33, 1, s30
    v_and_b32 v6, 7, v4
    v_xor_b32 v5, v5, v6
    v_lshlrev_b32 v5, 4, v5
    v_lshl_add_u32 v56, v4, 7, v5
    v_add_u32 v56, 81920, v56
    v_xor_b32 v57, 16, v56
    v_bfe_u32 v4, v2, 2, 2
    v_lshl_add_u32 v5, v33, 2, v4
    v_lshlrev_b32 v5, 7, v5
    v_lshrrev_b32 v6, 1, v4
    v_xor_b32 v6, s64, v6
    v_lshl_add_u32 v5, v6, 6, v5
    v_and_b32 v6, 1, v2
    v_lshl_add_u32 v5, v6, 5, v5
    v_and_b32 v6, 1, v29
    v_lshl_add_u32 v5, v6, 4, v5
    v_bfe_u32 v7, v2, 1, 1
    v_lshl_add_u32 v53, v7, 3, v5
    v_add_u32 v53, 81920, v53
    v_add_u32 v54, 0x8000, v53
    v_lshl_add_u32 v4, v33, 4, v4
    s_lshl_b32 s30, s64, 5
    v_add_u32 v4, s30, v4
    v_lshlrev_b32 v4, 7, v4
    v_lshl_add_u32 v4, v6, 5, v4
    v_and_b32 v5, 3, v2
    v_lshl_add_u32 v4, v5, 3, v4
    s_lshl_b32 s30, s63, 6
    s_add_u32 s30, s30, 65536
    v_add_u32 v55, s30, v4
    s_lshr_b32 s70, s88, 2
    s_lshl_b32 s70, s70, 12
    s_add_u32 s70, s70, 15007744
    s_lshl_b32 s91, s89, 12
    s_add_u32 s91, s91, 15040512
    s_nop 1
    s_add_u32 s22, s66, 0
    s_add_u32 m0, s68, 81920
    s_and_b32 s22, s22, 524287
    buffer_load_dwordx4 v50, s[48:51], s22 offen lds
    s_add_u32 s22, s66, 32768
    s_add_u32 m0, s68, 86016
    s_and_b32 s22, s22, 524287
    buffer_load_dwordx4 v50, s[48:51], s22 offen lds
    s_add_u32 s22, s66, 65536
    s_add_u32 m0, s68, 90112
    s_and_b32 s22, s22, 524287
    buffer_load_dwordx4 v50, s[48:51], s22 offen lds
    s_add_u32 s22, s66, 98304
    s_add_u32 m0, s68, 94208
    s_and_b32 s22, s22, 524287
    buffer_load_dwordx4 v50, s[48:51], s22 offen lds
    s_add_u32 s22, s66, 131072
    s_add_u32 m0, s68, 98304
    s_and_b32 s22, s22, 524287
    buffer_load_dwordx4 v50, s[48:51], s22 offen lds
    s_add_u32 s22, s66, 163840
    s_add_u32 m0, s68, 102400
    s_and_b32 s22, s22, 524287
    buffer_load_dwordx4 v50, s[48:51], s22 offen lds
    s_add_u32 s22, s66, 196608
    s_add_u32 m0, s68, 106496
    s_and_b32 s22, s22, 524287
    buffer_load_dwordx4 v50, s[48:51], s22 offen lds
    s_add_u32 s22, s66, 229376
    s_add_u32 m0, s68, 110592
    s_and_b32 s22, s22, 524287
    buffer_load_dwordx4 v50, s[48:51], s22 offen lds
    v_cmp_gt_u32 s[74:75], 32, v2
    s_waitcnt vmcnt(8) lgkmcnt(0)
    s_barrier
    s_cmp_eq_u32 s62, 0
    s_cbranch_scc0 LF_sig_o
    s_mov_b64 exec, 1
    v_mov_b32 v6, s93
    v_mov_b32 v7, 0
    buffer_store_dword v6, v7, s[44:47], s86 offen sc1
    s_mov_b64 exec, -1
LF_sig_o:
    s_add_u32 s22, s66, 262144
    s_add_u32 m0, s68, 114688
    s_and_b32 s22, s22, 524287
    buffer_load_dwordx4 v50, s[48:51], s22 offen lds
    s_add_u32 s22, s66, 294912
    s_add_u32 m0, s68, 118784
    s_and_b32 s22, s22, 524287
    buffer_load_dwordx4 v50, s[48:51], s22 offen lds
    s_add_u32 s22, s66, 327680
    s_add_u32 m0, s68, 122880
    s_and_b32 s22, s22, 524287
    buffer_load_dwordx4 v50, s[48:51], s22 offen lds
    s_add_u32 s22, s66, 360448
    s_add_u32 m0, s68, 126976
    s_and_b32 s22, s22, 524287
    buffer_load_dwordx4 v50, s[48:51], s22 offen lds
    s_add_u32 s22, s66, 393216
    s_add_u32 m0, s68, 131072
    s_and_b32 s22, s22, 524287
    buffer_load_dwordx4 v50, s[48:51], s22 offen lds
    s_add_u32 s22, s66, 425984
    s_add_u32 m0, s68, 135168
    s_and_b32 s22, s22, 524287
    buffer_load_dwordx4 v50, s[48:51], s22 offen lds
    s_add_u32 s22, s66, 458752
    s_add_u32 m0, s68, 139264
    s_and_b32 s22, s22, 524287
    buffer_load_dwordx4 v50, s[48:51], s22 offen lds
    s_add_u32 s22, s66, 491520
    s_add_u32 m0, s68, 143360
    s_and_b32 s22, s22, 524287
    buffer_load_dwordx4 v50, s[48:51], s22 offen lds
    s_add_u32 s22, s61, 0
    buffer_load_dword v16, v60, s[44:47], s22 offen
    s_add_u32 s22, s61, 8192
    buffer_load_dword v17, v60, s[44:47], s22 offen
    s_add_u32 s22, s61, 16384
    buffer_load_dword v18, v60, s[44:47], s22 offen
    s_add_u32 s22, s61, 24576
    buffer_load_dword v19, v60, s[44:47], s22 offen
    s_waitcnt vmcnt(4)
    s_barrier
    ds_read_b64_tr_b16 v[68:69], v53 offset:0
    ds_read_b64_tr_b16 v[70:71], v53 offset:1024
    ds_read_b64_tr_b16 v[72:73], v53 offset:2048
    ds_read_b64_tr_b16 v[74:75], v53 offset:3072
    ds_read_b64_tr_b16 v[76:77], v53 offset:4096
    ds_read_b64_tr_b16 v[78:79], v53 offset:5120
    ds_read_b64_tr_b16 v[80:81], v53 offset:6144
    ds_read_b64_tr_b16 v[82:83], v53 offset:7168
    ds_read_b64_tr_b16 v[84:85], v53 offset:8192
    ds_read_b64_tr_b16 v[86:87], v53 offset:9216
    ds_read_b64_tr_b16 v[88:89], v53 offset:10240
    ds_read_b64_tr_b16 v[90:91], v53 offset:11264
    ds_read_b64_tr_b16 v[92:93], v53 offset:12288
    ds_read_b64_tr_b16 v[94:95], v53 offset:13312
    ds_read_b64_tr_b16 v[96:97], v53 offset:14336
    ds_read_b64_tr_b16 v[98:99], v53 offset:15360
    ds_read_b64_tr_b16 v[100:101], v53 offset:16384
    ds_read_b64_tr_b16 v[102:103], v53 offset:17408
    ds_read_b64_tr_b16 v[104:105], v53 offset:18432
    ds_read_b64_tr_b16 v[106:107], v53 offset:19456
    ds_read_b64_tr_b16 v[108:109], v53 offset:20480
    ds_read_b64_tr_b16 v[110:111], v53 offset:21504
    ds_read_b64_tr_b16 v[112:113], v53 offset:22528
    ds_read_b64_tr_b16 v[114:115], v53 offset:23552
    ds_read_b64_tr_b16 v[116:117], v53 offset:24576
    ds_read_b64_tr_b16 v[118:119], v53 offset:25600
    ds_read_b64_tr_b16 v[120:121], v53 offset:26624
    ds_read_b64_tr_b16 v[122:123], v53 offset:27648
    ds_read_b64_tr_b16 v[124:125], v53 offset:28672
    ds_read_b64_tr_b16 v[126:127], v53 offset:29696
    ds_read_b64_tr_b16 v[128:129], v53 offset:30720
    ds_read_b64_tr_b16 v[130:131], v53 offset:31744
    ds_read_b64_tr_b16 v[132:133], v54 offset:0
    ds_read_b64_tr_b16 v[134:135], v54 offset:1024
    ds_read_b64_tr_b16 v[136:137], v54 offset:2048
    ds_read_b64_tr_b16 v[138:139], v54 offset:3072
    ds_read_b64_tr_b16 v[140:141], v54 offset:4096
    ds_read_b64_tr_b16 v[142:143], v54 offset:5120
    ds_read_b64_tr_b16 v[144:145], v54 offset:6144
    ds_read_b64_tr_b16 v[146:147], v54 offset:7168
    ds_read_b64_tr_b16 v[148:149], v54 offset:8192
    ds_read_b64_tr_b16 v[150:151], v54 offset:9216
    ds_read_b64_tr_b16 v[152:153], v54 offset:10240
    ds_read_b64_tr_b16 v[154:155], v54 offset:11264
    ds_read_b64_tr_b16 v[156:157], v54 offset:12288
    ds_read_b64_tr_b16 v[158:159], v54 offset:13312
    ds_read_b64_tr_b16 v[160:161], v54 offset:14336
    ds_read_b64_tr_b16 v[162:163], v54 offset:15360
    ds_read_b64_tr_b16 v[164:165], v54 offset:16384
    ds_read_b64_tr_b16 v[166:167], v54 offset:17408
    ds_read_b64_tr_b16 v[168:169], v54 offset:18432
    ds_read_b64_tr_b16 v[170:171], v54 offset:19456
    ds_read_b64_tr_b16 v[172:173], v54 offset:20480
    ds_read_b64_tr_b16 v[174:175], v54 offset:21504
    ds_read_b64_tr_b16 v[176:177], v54 offset:22528
    ds_read_b64_tr_b16 v[178:179], v54 offset:23552
    ds_read_b64_tr_b16 v[180:181], v54 offset:24576
    ds_read_b64_tr_b16 v[182:183], v54 offset:25600
    ds_read_b64_tr_b16 v[184:185], v54 offset:26624
    ds_read_b64_tr_b16 v[186:187], v54 offset:27648
    ds_read_b64_tr_b16 v[188:189], v54 offset:28672
    ds_read_b64_tr_b16 v[190:191], v54 offset:29696
    ds_read_b64_tr_b16 v[192:193], v54 offset:30720
    ds_read_b64_tr_b16 v[194:195], v54 offset:31744
    s_waitcnt lgkmcnt(0)
    s_cmp_eq_u32 s62, 0
    s_cbranch_scc0 LF_ob_skip
    v_mov_b32 v13, s70
    v_mov_b32 v4, s91
    v_cndmask_b32 v13, v4, v13, s[74:75]
    v_add_u32 v13, v13, v49
    buffer_load_dword v10, v13, s[44:47], 0 offen sc1
    s_waitcnt vmcnt(0)
    s_mov_b32 s90, 0
LF_ob_loop:
    v_cmp_eq_u32 vcc, s93, v10
    s_add_u32 s90, s90, 1
    s_cmp_eq_u64 vcc, -1
    s_cbranch_scc1 LF_ob_done
    s_sleep 4
    buffer_load_dword v10, v13, s[44:47], 0 offen sc1
    s_waitcnt vmcnt(0)
    s_cmp_lt_u32 s90, 65536
    s_cbranch_scc1 LF_ob_loop
LF_ob_done:
LF_ob_skip:
    s_barrier
    s_add_u32 s22, s67, 0
    s_and_b32 s22, s22, 32767
    s_add_u32 m0, s69, 0
    s_add_u32 s22, s22, s27
    buffer_load_dwordx4 v51, s[44:47], s22 offen lds
    s_add_u32 s22, s67, 2048
    s_and_b32 s22, s22, 32767
    s_add_u32 m0, s69, 2048
    s_add_u32 s22, s22, s27
    buffer_load_dwordx4 v51, s[44:47], s22 offen lds
    s_add_u32 s22, s67, 4096
    s_and_b32 s22, s22, 32767
    s_add_u32 m0, s69, 4096
    s_add_u32 s22, s22, s27
    buffer_load_dwordx4 v51, s[44:47], s22 offen lds
    s_add_u32 s22, s67, 6144
    s_and_b32 s22, s22, 32767
    s_add_u32 m0, s69, 6144
    s_add_u32 s22, s22, s27
    buffer_load_dwordx4 v51, s[44:47], s22 offen lds
    s_add_u32 s22, s67, 8192
    s_and_b32 s22, s22, 32767
    s_add_u32 m0, s69, 8192
    s_add_u32 s22, s22, s27
    buffer_load_dwordx4 v51, s[44:47], s22 offen lds
    s_add_u32 s22, s67, 10240
    s_and_b32 s22, s22, 32767
    s_add_u32 m0, s69, 10240
    s_add_u32 s22, s22, s27
    buffer_load_dwordx4 v51, s[44:47], s22 offen lds
    s_add_u32 s22, s67, 12288
    s_and_b32 s22, s22, 32767
    s_add_u32 m0, s69, 12288
    s_add_u32 s22, s22, s27
    buffer_load_dwordx4 v51, s[44:47], s22 offen lds
    s_add_u32 s22, s67, 14336
    s_and_b32 s22, s22, 32767
    s_add_u32 m0, s69, 14336
    s_add_u32 s22, s22, s27
    buffer_load_dwordx4 v51, s[44:47], s22 offen lds
    s_add_u32 s22, s67, 16384
    s_and_b32 s22, s22, 32767
    s_add_u32 m0, s69, 16384
    s_add_u32 s22, s22, s27
    buffer_load_dwordx4 v51, s[44:47], s22 offen lds
    s_add_u32 s22, s67, 18432
    s_and_b32 s22, s22, 32767
    s_add_u32 m0, s69, 18432
    s_add_u32 s22, s22, s27
    buffer_load_dwordx4 v51, s[44:47], s22 offen lds
    s_add_u32 s22, s67, 20480
    s_and_b32 s22, s22, 32767
    s_add_u32 m0, s69, 20480
    s_add_u32 s22, s22, s27
    buffer_load_dwordx4 v51, s[44:47], s22 offen lds
    s_add_u32 s22, s67, 22528
    s_and_b32 s22, s22, 32767
    s_add_u32 m0, s69, 22528
    s_add_u32 s22, s22, s27
    buffer_load_dwordx4 v51, s[44:47], s22 offen lds
    s_add_u32 s22, s67, 24576
    s_and_b32 s22, s22, 32767
    s_add_u32 m0, s69, 24576
    s_add_u32 s22, s22, s27
    buffer_load_dwordx4 v51, s[44:47], s22 offen lds
    s_add_u32 s22, s67, 26624
    s_and_b32 s22, s22, 32767
    s_add_u32 m0, s69, 26624
    s_add_u32 s22, s22, s27
    buffer_load_dwordx4 v51, s[44:47], s22 offen lds
    s_add_u32 s22, s67, 28672
    s_and_b32 s22, s22, 32767
    s_add_u32 m0, s69, 28672
    s_add_u32 s22, s22, s27
    buffer_load_dwordx4 v51, s[44:47], s22 offen lds
    s_add_u32 s22, s67, 30720
    s_and_b32 s22, s22, 32767
    s_add_u32 m0, s69, 30720
    s_add_u32 s22, s22, s27
    buffer_load_dwordx4 v51, s[44:47], s22 offen lds
    s_lshl_b32 s30, s62, 11
    s_add_u32 m0, s30, 65536
    s_nop 0
    buffer_load_dwordx4 v59, s[44:47], s60 offen lds
    s_add_u32 m0, s30, 66560
    s_add_u32 s22, s60, 32768
    buffer_load_dwordx4 v59, s[44:47], s22 offen lds
    s_waitcnt vmcnt(14)
    s_barrier
    ds_read_b128 v[212:215], v52 offset:0
    ds_read_b128 v[216:219], v52 offset:1024
    ds_read_b128 v[220:223], v52 offset:2048
    ds_read_b128 v[224:227], v52 offset:3072
    s_waitcnt lgkmcnt(3)
    v_mfma_f32_32x32x16_bf16 v[196:211], v[68:71], v[212:215], 0
    ds_read_b128 v[212:215], v52 offset:4096
    s_waitcnt lgkmcnt(3)
    v_mfma_f32_32x32x16_bf16 v[196:211], v[72:75], v[216:219], v[196:211]
    ds_read_b128 v[216:219], v52 offset:5120
    s_waitcnt lgkmcnt(3)
    v_mfma_f32_32x32x16_bf16 v[196:211], v[76:79], v[220:223], v[196:211]
    ds_read_b128 v[220:223], v52 offset:6144
    s_waitcnt lgkmcnt(3)
    v_mfma_f32_32x32x16_bf16 v[196:211], v[80:83], v[224:227], v[196:211]
    ds_read_b128 v[224:227], v52 offset:7168
    s_waitcnt lgkmcnt(3)
    v_mfma_f32_32x32x16_bf16 v[196:211], v[84:87], v[212:215], v[196:211]
    s_waitcnt lgkmcnt(2)
    v_mfma_f32_32x32x16_bf16 v[196:211], v[88:91], v[216:219], v[196:211]
    s_waitcnt lgkmcnt(1)
    v_mfma_f32_32x32x16_bf16 v[196:211], v[92:95], v[220:223], v[196:211]
    s_waitcnt lgkmcnt(0)
    v_mfma_f32_32x32x16_bf16 v[196:211], v[96:99], v[224:227], v[196:211]
    s_waitcnt vmcnt(10)
    s_barrier
    ds_read_b128 v[212:215], v52 offset:8192
    ds_read_b128 v[216:219], v52 offset:9216
    ds_read_b128 v[220:223], v52 offset:10240
    ds_read_b128 v[224:227], v52 offset:11264
    s_waitcnt lgkmcnt(3)
    v_mfma_f32_32x32x16_bf16 v[196:211], v[100:103], v[212:215], v[196:211]
    ds_read_b128 v[212:215], v52 offset:12288
    s_waitcnt lgkmcnt(3)
    v_mfma_f32_32x32x16_bf16 v[196:211], v[104:107], v[216:219], v[196:211]
    ds_read_b128 v[216:219], v52 offset:13312
    s_waitcnt lgkmcnt(3)
    v_mfma_f32_32x32x16_bf16 v[196:211], v[108:111], v[220:223], v[196:211]
    ds_read_b128 v[220:223], v52 offset:14336
    s_waitcnt lgkmcnt(3)
    v_mfma_f32_32x32x16_bf16 v[196:211], v[112:115], v[224:227], v[196:211]
    ds_read_b128 v[224:227], v52 offset:15360
    s_waitcnt lgkmcnt(3)
    v_mfma_f32_32x32x16_bf16 v[196:211], v[116:119], v[212:215], v[196:211]
    s_waitcnt lgkmcnt(2)
    v_mfma_f32_32x32x16_bf16 v[196:211], v[120:123], v[216:219], v[196:211]
    s_waitcnt lgkmcnt(1)
    v_mfma_f32_32x32x16_bf16 v[196:211], v[124:127], v[220:223], v[196:211]
    s_waitcnt lgkmcnt(0)
    v_mfma_f32_32x32x16_bf16 v[196:211], v[128:131], v[224:227], v[196:211]
    s_waitcnt vmcnt(6)
    s_barrier
    ds_read_b128 v[212:215], v52 offset:16384
    ds_read_b128 v[216:219], v52 offset:17408
    ds_read_b128 v[220:223], v52 offset:18432
    ds_read_b128 v[224:227], v52 offset:19456
    s_waitcnt lgkmcnt(3)
    v_mfma_f32_32x32x16_bf16 v[196:211], v[132:135], v[212:215], v[196:211]
    ds_read_b128 v[212:215], v52 offset:20480
    s_waitcnt lgkmcnt(3)
    v_mfma_f32_32x32x16_bf16 v[196:211], v[136:139], v[216:219], v[196:211]
    ds_read_b128 v[216:219], v52 offset:21504
    s_waitcnt lgkmcnt(3)
    v_mfma_f32_32x32x16_bf16 v[196:211], v[140:143], v[220:223], v[196:211]
    ds_read_b128 v[220:223], v52 offset:22528
    s_waitcnt lgkmcnt(3)
    v_mfma_f32_32x32x16_bf16 v[196:211], v[144:147], v[224:227], v[196:211]
    ds_read_b128 v[224:227], v52 offset:23552
    s_waitcnt lgkmcnt(3)
    v_mfma_f32_32x32x16_bf16 v[196:211], v[148:151], v[212:215], v[196:211]
    s_waitcnt lgkmcnt(2)
    v_mfma_f32_32x32x16_bf16 v[196:211], v[152:155], v[216:219], v[196:211]
    s_waitcnt lgkmcnt(1)
    v_mfma_f32_32x32x16_bf16 v[196:211], v[156:159], v[220:223], v[196:211]
    s_waitcnt lgkmcnt(0)
    v_mfma_f32_32x32x16_bf16 v[196:211], v[160:163], v[224:227], v[196:211]
    s_waitcnt vmcnt(2)
    s_barrier
    ds_read_b128 v[212:215], v52 offset:24576
    ds_read_b128 v[216:219], v52 offset:25600
    ds_read_b128 v[220:223], v52 offset:26624
    ds_read_b128 v[224:227], v52 offset:27648
    s_waitcnt lgkmcnt(3)
    v_mfma_f32_32x32x16_bf16 v[196:211], v[164:167], v[212:215], v[196:211]
    ds_read_b128 v[212:215], v52 offset:28672
    s_waitcnt lgkmcnt(3)
    v_mfma_f32_32x32x16_bf16 v[196:211], v[168:171], v[216:219], v[196:211]
    ds_read_b128 v[216:219], v52 offset:29696
    s_waitcnt lgkmcnt(3)
    v_mfma_f32_32x32x16_bf16 v[196:211], v[172:175], v[220:223], v[196:211]
    ds_read_b128 v[220:223], v52 offset:30720
    s_waitcnt lgkmcnt(3)
    v_mfma_f32_32x32x16_bf16 v[196:211], v[176:179], v[224:227], v[196:211]
    ds_read_b128 v[224:227], v52 offset:31744
    s_waitcnt lgkmcnt(3)
    v_mfma_f32_32x32x16_bf16 v[196:211], v[180:183], v[212:215], v[196:211]
    s_waitcnt lgkmcnt(2)
    v_mfma_f32_32x32x16_bf16 v[196:211], v[184:187], v[216:219], v[196:211]
    s_waitcnt lgkmcnt(1)
    v_mfma_f32_32x32x16_bf16 v[196:211], v[188:191], v[220:223], v[196:211]
    s_waitcnt lgkmcnt(0)
    v_mfma_f32_32x32x16_bf16 v[196:211], v[192:195], v[224:227], v[196:211]
    v_add_f32 v16, v16, v17
    v_add_f32 v18, v18, v19
    v_add_f32 v16, v16, v18
    v_mov_b32 v17, v16
    s_nop 1
    v_permlane32_swap_b32 v16, v17
    v_add_f32 v14, v16, v17
    v_mul_f32 v14, 0xbfb8aa3b, v14
    v_exp_f32 v14, v14
    s_nop 0
    v_add_f32 v14, 1.0, v14
    v_rcp_f32 v14, v14
    s_waitcnt vmcnt(0)
    s_barrier
    ds_read_b64_tr_b16 v[68:69], v55 offset:0
    ds_read_b64_tr_b16 v[70:71], v55 offset:512
    ds_read_b64_tr_b16 v[72:73], v55 offset:1024
    ds_read_b64_tr_b16 v[74:75], v55 offset:1536
    s_waitcnt lgkmcnt(0)
    v_lshlrev_b32 v76, 16, v68
    v_and_b32 v77, 0xffff0000, v68
    v_lshlrev_b32 v78, 16, v69
    v_and_b32 v79, 0xffff0000, v69
    v_lshlrev_b32 v80, 16, v70
    v_and_b32 v81, 0xffff0000, v70
    v_lshlrev_b32 v82, 16, v71
    v_and_b32 v83, 0xffff0000, v71
    v_lshlrev_b32 v84, 16, v72
    v_and_b32 v85, 0xffff0000, v72
    v_lshlrev_b32 v86, 16, v73
    v_and_b32 v87, 0xffff0000, v73
    v_lshlrev_b32 v88, 16, v74
    v_and_b32 v89, 0xffff0000, v74
    v_lshlrev_b32 v90, 16, v75
    v_and_b32 v91, 0xffff0000, v75
    v_pk_add_f32 v[196:197], v[196:197], v[76:77] neg_lo:[0,1] neg_hi:[0,1]
    v_pk_add_f32 v[198:199], v[198:199], v[78:79] neg_lo:[0,1] neg_hi:[0,1]
    v_pk_add_f32 v[200:201], v[200:201], v[80:81] neg_lo:[0,1] neg_hi:[0,1]
    v_pk_add_f32 v[202:203], v[202:203], v[82:83] neg_lo:[0,1] neg_hi:[0,1]
    v_pk_add_f32 v[204:205], v[204:205], v[84:85] neg_lo:[0,1] neg_hi:[0,1]
    v_pk_add_f32 v[206:207], v[206:207], v[86:87] neg_lo:[0,1] neg_hi:[0,1]
    v_pk_add_f32 v[208:209], v[208:209], v[88:89] neg_lo:[0,1] neg_hi:[0,1]
    v_pk_add_f32 v[210:211], v[210:211], v[90:91] neg_lo:[0,1] neg_hi:[0,1]
    v_pk_fma_f32 v[76:77], v[196:197], v[14:15], v[76:77] op_sel_hi:[1,0,1]
    v_pk_fma_f32 v[78:79], v[198:199], v[14:15], v[78:79] op_sel_hi:[1,0,1]
    v_pk_fma_f32 v[80:81], v[200:201], v[14:15], v[80:81] op_sel_hi:[1,0,1]
    v_pk_fma_f32 v[82:83], v[202:203], v[14:15], v[82:83] op_sel_hi:[1,0,1]
    v_pk_fma_f32 v[84:85], v[204:205], v[14:15], v[84:85] op_sel_hi:[1,0,1]
    v_pk_fma_f32 v[86:87], v[206:207], v[14:15], v[86:87] op_sel_hi:[1,0,1]
    v_pk_fma_f32 v[88:89], v[208:209], v[14:15], v[88:89] op_sel_hi:[1,0,1]
    v_pk_fma_f32 v[90:91], v[210:211], v[14:15], v[90:91] op_sel_hi:[1,0,1]
    v_cvt_pk_bf16_f32 v68, v76, v77
    v_cvt_pk_bf16_f32 v69, v78, v79
    v_cvt_pk_bf16_f32 v70, v80, v81
    v_cvt_pk_bf16_f32 v71, v82, v83
    v_cvt_pk_bf16_f32 v72, v84, v85
    v_cvt_pk_bf16_f32 v73, v86, v87
    v_cvt_pk_bf16_f32 v74, v88, v89
    v_cvt_pk_bf16_f32 v75, v90, v91
    ds_write_b128 v56, v[68:71]
    ds_write_b128 v57, v[72:75]
    s_waitcnt lgkmcnt(0)
    s_barrier
    ds_read_b128 v[100:103], v58 offset:0
    ds_read_b128 v[104:107], v58 offset:1024
    s_add_u32 s22, s65, 8192
    s_waitcnt lgkmcnt(1)
    buffer_store_dwordx4 v[100:103], v61, s[52:55], s65 offen
    s_waitcnt lgkmcnt(0)
    buffer_store_dwordx4 v[104:107], v61, s[52:55], s22 offen
    s_endpgm
L1_exit:
    s_endpgm
.p2align 8
L2c_gtab:
.short 2560, 2560, 2560, 2560, 2556, 2556, 2556, 2556, 2556, 2556, 2556, 2540, 2540, 2540, 2540, 2540
.short 2540, 2540, 2540, 2540, 2524, 2524, 2524, 2524, 2524, 2524, 2524, 2508, 2508, 2508, 2508, 2508
.short 2508, 2508, 2508, 2508, 2492, 2492, 2492, 2492, 2492, 2492, 2492, 2476, 2476, 2476, 2476, 2476
.short 2476, 2476, 2476, 2476, 2460, 2460, 2460, 2460, 2460, 2460, 2460, 2444, 2444, 2444, 2444, 2444
.short 2444, 2444, 2444, 2444, 2428, 2428, 2428, 2428, 2428, 2428, 2428, 2412, 2412, 2412, 2412, 2412
.short 2412, 2412, 2412, 2412, 2396, 2396, 2396, 2396, 2396, 2396, 2396, 2380, 2380, 2380, 2380, 2380
.short 2380, 2380, 2380, 2380, 2364, 2364, 2364, 2364, 2364, 2364, 2364, 2348, 2348, 2348, 2348, 2348
.short 2348, 2348, 2348, 2348, 2332, 2332, 2332, 2332, 2332, 2332, 2332, 2316, 2316, 2316, 2316, 2316
.short 2316, 2316, 2316, 2316, 2552, 2552, 2552, 2552, 2552, 2552, 2552, 2536, 2536, 2536, 2536, 2536
.short 2536, 2536, 2536, 2536, 2520, 2520, 2520, 2520, 2520, 2520, 2520, 2504, 2504, 2504, 2504, 2504
.short 2504, 2504, 2504, 2504, 2488, 2488, 2488, 2488, 2488, 2488, 2488, 2472, 2472, 2472, 2472, 2472
.short 2472, 2472, 2472, 2472, 2456, 2456, 2456, 2456, 2456, 2456, 2456, 2440, 2440, 2440, 2440, 2440
.short 2440, 2440, 2440, 2440, 2424, 2424, 2424, 2424, 2424, 2424, 2424, 2408, 2408, 2408, 2408, 2408
.short 2408, 2408, 2408, 2408, 2392, 2392, 2392, 2392, 2392, 2392, 2392, 2376, 2376, 2376, 2376, 2376
.short 2376, 2376, 2376, 2376, 2360, 2360, 2360, 2360, 2360, 2360, 2360, 2344, 2344, 2344, 2344, 2344
.short 2344, 2344, 2344, 2344, 2328, 2328, 2328, 2328, 2328, 2328, 2328, 2312, 2312, 2312, 2312, 2312
.short 2312, 2312, 2312, 2312, 2548, 2548, 2548, 2548, 2548, 2548, 2548, 2532, 2532, 2532, 2532, 2532
.short 2532, 2532, 2532, 2532, 2516, 2516, 2516, 2516, 2516, 2516, 2516, 2500, 2500, 2500, 2500, 2500
.short 2500, 2500, 2500, 2500, 2484, 2484, 2484, 2484, 2484, 2484, 2484, 2468, 2468, 2468, 2468, 2468
.short 2468, 2468, 2468, 2468, 2452, 2452, 2452, 2452, 2452, 2452, 2452, 2436, 2436, 2436, 2436, 2436
.short 2436, 2436, 2436, 2436, 2420, 2420, 2420, 2420, 2420, 2420, 2420, 2404, 2404, 2404, 2404, 2404
.short 2404, 2404, 2404, 2404, 2388, 2388, 2388, 2388, 2388, 2388, 2388, 2372, 2372, 2372, 2372, 2372
.short 2372, 2372, 2372, 2372, 2356, 2356, 2356, 2356, 2356, 2356, 2356, 2340, 2340, 2340, 2340, 2340
.short 2340, 2340, 2340, 2340, 2324, 2324, 2324, 2324, 2324, 2324, 2324, 2308, 2308, 2308, 2308, 2308
.short 2308, 2308, 2308, 2308, 2544, 2544, 2544, 2544, 2544, 2544, 2544, 2528, 2528, 2528, 2528, 2528
.short 2528, 2528, 2528, 2528, 2512, 2512, 2512, 2512, 2512, 2512, 2512, 2496, 2496, 2496, 2496, 2496
.short 2496, 2496, 2496, 2496, 2480, 2480, 2480, 2480, 2480, 2480, 2480, 2464, 2464, 2464, 2464, 2464
.short 2464, 2464, 2464, 2464, 2448, 2448, 2448, 2448, 2448, 2448, 2448, 2432, 2432, 2432, 2432, 2432
.short 2432, 2432, 2432, 2432, 2416, 2416, 2416, 2416, 2416, 2416, 2416, 2400, 2400, 2400, 2400, 2400
.short 2400, 2400, 2400, 2400, 2384, 2384, 2384, 2384, 2384, 2384, 2384, 2368, 2368, 2368, 2368, 2368
.short 2368, 2368, 2368, 2368, 2352, 2352, 2352, 2352, 2352, 2352, 2352, 2336, 2336, 2336, 2336, 2336
.short 2336, 2336, 2336, 2336, 2320, 2320, 2320, 2320, 2320, 2320, 2320, 2304, 2304, 2304, 2304, 2304
.short 2556, 2556, 2556, 2048, 2048, 2044, 2044, 2044, 2540, 2540, 2540, 2040, 2040, 2028, 2028, 2028
.short 2524, 2524, 2524, 2024, 2024, 2012, 2012, 2012, 2508, 2508, 2508, 2008, 2008, 1996, 1996, 1996
.short 2492, 2492, 2492, 1992, 1992, 1980, 1980, 1980, 2476, 2476, 2476, 1976, 1976, 1964, 1964, 1964
.short 2460, 2460, 2460, 1960, 1960, 1948, 1948, 1948, 2444, 2444, 2444, 1944, 1944, 1932, 1932, 1932
.short 2428, 2428, 2428, 1928, 1928, 1916, 1916, 1916, 2412, 2412, 2412, 1912, 1912, 1900, 1900, 1900
.short 2396, 2396, 2396, 1896, 1896, 1884, 1884, 1884, 2380, 2380, 2380, 1880, 1880, 1868, 1868, 1868
.short 2364, 2364, 2364, 1864, 1864, 1852, 1852, 1852, 2348, 2348, 2348, 1848, 1848, 1836, 1836, 1836
.short 2332, 2332, 2332, 1832, 1832, 1820, 1820, 1820, 2316, 2316, 2316, 1816, 1816, 1804, 1804, 1804
.short 2552, 2552, 2552, 1800, 1800, 2036, 2036, 2036, 2536, 2536, 2536, 2032, 2032, 2020, 2020, 2020
.short 2520, 2520, 2520, 2016, 2016, 2004, 2004, 2004, 2504, 2504, 2504, 2000, 2000, 1988, 1988, 1988
.short 2488, 2488, 2488, 1984, 1984, 1972, 1972, 1972, 2472, 2472, 2472, 1968, 1968, 1956, 1956, 1956
.short 2456, 2456, 2456, 1952, 1952, 1940, 1940, 1940, 2440, 2440, 2440, 1936, 1936, 1924, 1924, 1924
.short 2424, 2424, 2424, 1920, 1920, 1908, 1908, 1908, 2408, 2408, 2408, 1904, 1904, 1892, 1892, 1892
.short 2392, 2392, 2392, 1888, 1888, 1876, 1876, 1876, 2376, 2376, 2376, 1872, 1872, 1860, 1860, 1860
.short 2360, 2360, 2360, 1856, 1856, 1844, 1844, 1844, 2344, 2344, 2344, 1840, 1840, 1828, 1828, 1828
.short 2328, 2328, 2328, 1824, 1824, 1812, 1812, 1812, 2312, 2312, 2312, 1808, 1808, 1796, 1796, 1796
.short 2548, 2548, 2548, 1792, 1792, 1788, 1788, 1788, 2532, 2532, 2532, 1784, 1784, 1772, 1772, 1772
.short 2516, 2516, 2516, 1768, 1768, 1756, 1756, 1756, 2500, 2500, 2500, 1752, 1752, 1740, 1740, 1740
.short 2484, 2484, 2484, 1736, 1736, 1724, 1724, 1724, 2468, 2468, 2468, 1720, 1720, 1708, 1708, 1708
.short 2452, 2452, 2452, 1704, 1704, 1692, 1692, 1692, 2436, 2436, 2436, 1688, 1688, 1676, 1676, 1676
.short 2420, 2420, 2420, 1672, 1672, 1660, 1660, 1660, 2404, 2404, 2404, 1656, 1656, 1644, 1644, 1644
.short 2388, 2388, 2388, 1640, 1640, 1628, 1628, 1628, 2372, 2372, 2372, 1624, 1624, 1612, 1612, 1612
.short 2356, 2356, 2356, 1608, 1608, 1596, 1596, 1596, 2340, 2340, 2340, 1592, 1592, 1580, 1580, 1580
.short 2324, 2324, 2324, 1576, 1576, 1564, 1564, 1564, 2308, 2308, 2308, 1560, 1560, 1548, 1548, 1548
.short 2544, 2544, 2544, 1544, 1544, 1780, 1780, 1780, 2528, 2528, 2528, 1776, 1776, 1764, 1764, 1764
.short 2512, 2512, 2512, 1760, 1760, 1748, 1748, 1748, 2496, 2496, 2496, 1744, 1744, 1732, 1732, 1732
.short 2480, 2480, 2480, 1728, 1728, 1716, 1716, 1716, 2464, 2464, 2464, 1712, 1712, 1700, 1700, 1700
.short 2448, 2448, 2448, 1696, 1696, 1684, 1684, 1684, 2432, 2432, 2432, 1680, 1680, 1668, 1668, 1668
.short 2416, 2416, 2416, 1664, 1664, 1652, 1652, 1652, 2400, 2400, 2400, 1648, 1648, 1636, 1636, 1636
.short 2384, 2384, 2384, 1632, 1632, 1620, 1620, 1620, 2368, 2368, 2368, 1616, 1616, 1604, 1604, 1604
.short 2352, 2352, 2352, 1600, 1600, 1588, 1588, 1588, 2336, 2336, 2336, 1584, 1584, 1572, 1572, 1572
.short 2320, 2320, 2320, 1568, 1568, 1556, 1556, 1556, 2304, 2304, 2304, 1552, 1552, 1540, 1540, 1540
.short 2040, 2040, 2040, 2040, 2040, 2028, 0, 0, 2024, 2024, 2024, 2024, 2024, 2012, 0, 0
.short 2008, 2008, 2008, 2008, 2008, 1996, 0, 0, 1992, 1992, 1992, 1992, 1992, 1980, 0, 0
.short 1976, 1976, 1976, 1976, 1976, 1964, 0, 0, 1960, 1960, 1960, 1960, 1960, 1948, 0, 0
.short 1944, 1944, 1944, 1944, 1944, 1932, 0, 0, 1928, 1928, 1928, 1928, 1928, 1916, 0, 0
.short 1912, 1912, 1912, 1912, 1912, 1900, 0, 0, 1896, 1896, 1896, 1896, 1896, 1884, 0, 0
.short 1880, 1880, 1880, 1880, 1880, 1868, 0, 0, 1864, 1864, 1864, 1864, 1864, 1852, 0, 0
.short 1848, 1848, 1848, 1848, 1848, 1836, 0, 0, 1832, 1832, 1832, 1832, 1832, 1820, 0, 0
.short 1816, 1816, 1816, 1816, 1816, 1804, 0, 0, 1800, 1800, 1800, 1800, 1800, 2036, 0, 0
.short 2032, 2032, 2032, 2032, 2032, 2020, 0, 0, 2016, 2016, 2016, 2016, 2016, 2004, 0, 0
.short 2000, 2000, 2000, 2000, 2000, 1988, 0, 0, 1984, 1984, 1984, 1984, 1984, 1972, 0, 0
.short 1968, 1968, 1968, 1968, 1968, 1956, 0, 0, 1952, 1952, 1952, 1952, 1952, 1940, 0, 0
.short 1936, 1936, 1936, 1936, 1936, 1924, 0, 0, 1920, 1920, 1920, 1920, 1920, 1908, 0, 0
.short 1904, 1904, 1904, 1904, 1904, 1892, 0, 0, 1888, 1888, 1888, 1888, 1888, 1876, 0, 0
.short 1872, 1872, 1872, 1872, 1872, 1860, 0, 0, 1856, 1856, 1856, 1856, 1856, 1844, 0, 0
.short 1840, 1840, 1840, 1840, 1840, 1828, 0, 0, 1824, 1824, 1824, 1824, 1824, 1812, 0, 0
.short 1808, 1808, 1808, 1808, 1808, 1796, 0, 0, 1792, 1792, 1792, 1792, 1792, 1788, 0, 0
.short 1784, 1784, 1784, 1784, 1784, 1772, 0, 0, 1768, 1768, 1768, 1768, 1768, 1756, 0, 0
.short 1752, 1752, 1752, 1752, 1752, 1740, 0, 0, 1736, 1736, 1736, 1736, 1736, 1724, 0, 0
.short 1720, 1720, 1720, 1720, 1720, 1708, 0, 0, 1704, 1704, 1704, 1704, 1704, 1692, 0, 0
.short 1688, 1688, 1688, 1688, 1688, 1676, 0, 0, 1672, 1672, 1672, 1672, 1672, 1660, 0, 0
.short 1656, 1656, 1656, 1656, 1656, 1644, 0, 0, 1640, 1640, 1640, 1640, 1640, 1628, 0, 0
.short 1624, 1624, 1624, 1624, 1624, 1612, 0, 0, 1608, 1608, 1608, 1608, 1608, 1596, 0, 0
.short 1592, 1592, 1592, 1592, 1592, 1580, 0, 0, 1576, 1576, 1576, 1576, 1576, 1564, 0, 0
.short 1560, 1560, 1560, 1560, 1560, 1548, 0, 0, 1544, 1544, 1544, 1544, 1544, 1780, 0, 0
.short 1776, 1776, 1776, 1776, 1776, 1764, 0, 0, 1760, 1760, 1760, 1760, 1760, 1748, 0, 0
.short 1744, 1744, 1744, 1744, 1744, 1732, 0, 0, 1728, 1728, 1728, 1728, 1728, 1716, 0, 0
.short 1712, 1712, 1712, 1712, 1712, 1700, 0, 0, 1696, 1696, 1696, 1696, 1696, 1684, 0, 0
.short 1680, 1680, 1680, 1680, 1680, 1668, 0, 0, 1664, 1664, 1664, 1664, 1664, 1652, 0, 0
.short 1648, 1648, 1648, 1648, 1648, 1636, 0, 0, 1632, 1632, 1632, 1632, 1632, 1620, 0, 0
.short 1616, 1616, 1616, 1616, 1616, 1604, 0, 0, 1600, 1600, 1600, 1600, 1600, 1588, 0, 0
.short 1584, 1584, 1584, 1584, 1584, 1572, 0, 0, 1568, 1568, 1568, 1568, 1568, 1556, 0, 0
.short 1552, 1552, 1552, 1552, 1552, 1540, 0, 0, 1536, 1536, 1536, 1536, 1532, 1528, 0, 0
.short 2304, 2304, 2304, 2304, 2300, 2300, 2300, 2300, 2300, 2300, 2300, 2284, 2284, 2284, 2284, 2284
.short 2284, 2284, 2284, 2284, 2268, 2268, 2268, 2268, 2268, 2268, 2268, 2252, 2252, 2252, 2252, 2252
.short 2252, 2252, 2252, 2252, 2236, 2236, 2236, 2236, 2236, 2236, 2236, 2220, 2220, 2220, 2220, 2220
.short 2220, 2220, 2220, 2220, 2204, 2204, 2204, 2204, 2204, 2204, 2204, 2188, 2188, 2188, 2188, 2188
.short 2188, 2188, 2188, 2188, 2172, 2172, 2172, 2172, 2172, 2172, 2172, 2156, 2156, 2156, 2156, 2156
.short 2156, 2156, 2156, 2156, 2140, 2140, 2140, 2140, 2140, 2140, 2140, 2124, 2124, 2124, 2124, 2124
.short 2124, 2124, 2124, 2124, 2108, 2108, 2108, 2108, 2108, 2108, 2108, 2092, 2092, 2092, 2092, 2092
.short 2092, 2092, 2092, 2092, 2076, 2076, 2076, 2076, 2076, 2076, 2076, 2060, 2060, 2060, 2060, 2060
.short 2060, 2060, 2060, 2060, 2296, 2296, 2296, 2296, 2296, 2296, 2296, 2280, 2280, 2280, 2280, 2280
.short 2280, 2280, 2280, 2280, 2264, 2264, 2264, 2264, 2264, 2264, 2264, 2248, 2248, 2248, 2248, 2248
.short 2248, 2248, 2248, 2248, 2232, 2232, 2232, 2232, 2232, 2232, 2232, 2216, 2216, 2216, 2216, 2216
.short 2216, 2216, 2216, 2216, 2200, 2200, 2200, 2200, 2200, 2200, 2200, 2184, 2184, 2184, 2184, 2184
.short 2184, 2184, 2184, 2184, 2168, 2168, 2168, 2168, 2168, 2168, 2168, 2152, 2152, 2152, 2152, 2152
.short 2152, 2152, 2152, 2152, 2136, 2136, 2136, 2136, 2136, 2136, 2136, 2120, 2120, 2120, 2120, 2120
.short 2120, 2120, 2120, 2120, 2104, 2104, 2104, 2104, 2104, 2104, 2104, 2088, 2088, 2088, 2088, 2088
.short 2088, 2088, 2088, 2088, 2072, 2072, 2072, 2072, 2072, 2072, 2072, 2056, 2056, 2056, 2056, 2056
.short 2056, 2056, 2056, 2056, 2292, 2292, 2292, 2292, 2292, 2292, 2292, 2276, 2276, 2276, 2276, 2276
.short 2276, 2276, 2276, 2276, 2260, 2260, 2260, 2260, 2260, 2260, 2260, 2244, 2244, 2244, 2244, 2244
.short 2244, 2244, 2244, 2244, 2228, 2228, 2228, 2228, 2228, 2228, 2228, 2212, 2212, 2212, 2212, 2212
.short 2212, 2212, 2212, 2212, 2196, 2196, 2196, 2196, 2196, 2196, 2196, 2180, 2180, 2180, 2180, 2180
.short 2180, 2180, 2180, 2180, 2164, 2164, 2164, 2164, 2164, 2164, 2164, 2148, 2148, 2148, 2148, 2148
.short 2148, 2148, 2148, 2148, 2132, 2132, 2132, 2132, 2132, 2132, 2132, 2116, 2116, 2116, 2116, 2116
.short 2116, 2116, 2116, 2116, 2100, 2100, 2100, 2100, 2100, 2100, 2100, 2084, 2084, 2084, 2084, 2084
.short 2084, 2084, 2084, 2084, 2068, 2068, 2068, 2068, 2068, 2068, 2068, 2052, 2052, 2052, 2052, 2052
.short 2052, 2052, 2052, 2052, 2288, 2288, 2288, 2288, 2288, 2288, 2288, 2272, 2272, 2272, 2272, 2272
.short 2272, 2272, 2272, 2272, 2256, 2256, 2256, 2256, 2256, 2256, 2256, 2240, 2240, 2240, 2240, 2240
.short 2240, 2240, 2240, 2240, 2224, 2224, 2224, 2224, 2224, 2224, 2224, 2208, 2208, 2208, 2208, 2208
.short 2208, 2208, 2208, 2208, 2192, 2192, 2192, 2192, 2192, 2192, 2192, 2176, 2176, 2176, 2176, 2176
.short 2176, 2176, 2176, 2176, 2160, 2160, 2160, 2160, 2160, 2160, 2160, 2144, 2144, 2144, 2144, 2144
.short 2144, 2144, 2144, 2144, 2128, 2128, 2128, 2128, 2128, 2128, 2128, 2112, 2112, 2112, 2112, 2112
.short 2112, 2112, 2112, 2112, 2096, 2096, 2096, 2096, 2096, 2096, 2096, 2080, 2080, 2080, 2080, 2080
.short 2080, 2080, 2080, 2080, 2064, 2064, 2064, 2064, 2064, 2064, 2064, 2048, 2048, 2048, 2048, 2048
.short 2300, 2300, 2300, 1536, 1532, 1528, 1528, 1528, 2284, 2284, 2284, 1520, 1516, 1512, 1512, 1512
.short 2268, 2268, 2268, 1504, 1500, 1496, 1496, 1496, 2252, 2252, 2252, 1488, 1484, 1480, 1480, 1480
.short 2236, 2236, 2236, 1472, 1468, 1464, 1464, 1464, 2220, 2220, 2220, 1456, 1452, 1448, 1448, 1448
.short 2204, 2204, 2204, 1440, 1436, 1432, 1432, 1432, 2188, 2188, 2188, 1424, 1420, 1416, 1416, 1416
.short 2172, 2172, 2172, 1408, 1404, 1400, 1400, 1400, 2156, 2156, 2156, 1392, 1388, 1384, 1384, 1384
.short 2140, 2140, 2140, 1376, 1372, 1368, 1368, 1368, 2124, 2124, 2124, 1360, 1356, 1352, 1352, 1352
.short 2108, 2108, 2108, 1344, 1340, 1336, 1336, 1336, 2092, 2092, 2092, 1328, 1324, 1320, 1320, 1320
.short 2076, 2076, 2076, 1312, 1308, 1304, 1304, 1304, 2060, 2060, 2060, 1296, 1292, 1288, 1288, 1288
.short 2296, 2296, 2296, 1280, 1276, 1272, 1272, 1272, 2280, 2280, 2280, 1264, 1260, 1256, 1256, 1256
.short 2264, 2264, 2264, 1248, 1244, 1240, 1240, 1240, 2248, 2248, 2248, 1232, 1228, 1224, 1224, 1224
.short 2232, 2232, 2232, 1216, 1212, 1208, 1208, 1208, 2216, 2216, 2216, 1200, 1196, 1192, 1192, 1192
.short 2200, 2200, 2200, 1184, 1180, 1176, 1176, 1176, 2184, 2184, 2184, 1168, 1164, 1160, 1160, 1160
.short 2168, 2168, 2168, 1152, 1148, 1144, 1144, 1144, 2152, 2152, 2152, 1136, 1132, 1128, 1128, 1128
.short 2136, 2136, 2136, 1120, 1116, 1112, 1112, 1112, 2120, 2120, 2120, 1104, 1100, 1096, 1096, 1096
.short 2104, 2104, 2104, 1088, 1084, 1080, 1080, 1080, 2088, 2088, 2088, 1072, 1068, 1064, 1064, 1064
.short 2072, 2072, 2072, 1056, 1052, 1048, 1048, 1048, 2056, 2056, 2056, 1040, 1036, 1032, 1032, 1032
.short 2292, 2292, 2292, 1020, 1016, 1012, 1008, 764, 2276, 2276, 2276, 1004, 1000, 996, 992, 748
.short 2260, 2260, 2260, 988, 984, 980, 976, 732, 2244, 2244, 2244, 972, 968, 964, 960, 716
.short 2228, 2228, 2228, 956, 952, 948, 944, 700, 2212, 2212, 2212, 940, 936, 932, 928, 684
.short 2196, 2196, 2196, 924, 920, 916, 912, 668, 2180, 2180, 2180, 908, 904, 900, 896, 652
.short 2164, 2164, 2164, 892, 888, 884, 880, 636, 2148, 2148, 2148, 876, 872, 868, 864, 620
.short 2132, 2132, 2132, 860, 856, 852, 848, 604, 2116, 2116, 2116, 844, 840, 836, 832, 588
.short 2100, 2100, 2100, 828, 824, 820, 816, 572, 2084, 2084, 2084, 812, 808, 804, 800, 556
.short 2068, 2068, 2068, 796, 792, 788, 784, 540, 2052, 2052, 2052, 780, 776, 772, 768, 524
.short 2288, 2288, 2288, 508, 504, 500, 496, 252, 2272, 2272, 2272, 492, 488, 484, 480, 236
.short 2256, 2256, 2256, 476, 472, 468, 464, 220, 2240, 2240, 2240, 460, 456, 452, 448, 204
.short 2224, 2224, 2224, 444, 440, 436, 432, 188, 2208, 2208, 2208, 428, 424, 420, 416, 172
.short 2192, 2192, 2192, 412, 408, 404, 400, 156, 2176, 2176, 2176, 396, 392, 388, 384, 140
.short 2160, 2160, 2160, 380, 376, 372, 368, 124, 2144, 2144, 2144, 364, 360, 356, 352, 108
.short 2128, 2128, 2128, 348, 344, 340, 336, 92, 2112, 2112, 2112, 332, 328, 324, 320, 76
.short 2096, 2096, 2096, 316, 312, 308, 304, 60, 2080, 2080, 2080, 300, 296, 292, 288, 44
.short 2064, 2064, 2064, 284, 280, 276, 272, 28, 2048, 2048, 2044, 268, 264, 260, 256, 12
.short 1524, 1520, 1520, 1520, 1516, 1512, 0, 0, 1508, 1504, 1504, 1504, 1500, 1496, 0, 0
.short 1492, 1488, 1488, 1488, 1484, 1480, 0, 0, 1476, 1472, 1472, 1472, 1468, 1464, 0, 0
.short 1460, 1456, 1456, 1456, 1452, 1448, 0, 0, 1444, 1440, 1440, 1440, 1436, 1432, 0, 0
.short 1428, 1424, 1424, 1424, 1420, 1416, 0, 0, 1412, 1408, 1408, 1408, 1404, 1400, 0, 0
.short 1396, 1392, 1392, 1392, 1388, 1384, 0, 0, 1380, 1376, 1376, 1376, 1372, 1368, 0, 0
.short 1364, 1360, 1360, 1360, 1356, 1352, 0, 0, 1348, 1344, 1344, 1344, 1340, 1336, 0, 0
.short 1332, 1328, 1328, 1328, 1324, 1320, 0, 0, 1316, 1312, 1312, 1312, 1308, 1304, 0, 0
.short 1300, 1296, 1296, 1296, 1292, 1288, 0, 0, 1284, 1280, 1280, 1280, 1276, 1272, 0, 0
.short 1268, 1264, 1264, 1264, 1260, 1256, 0, 0, 1252, 1248, 1248, 1248, 1244, 1240, 0, 0
.short 1236, 1232, 1232, 1232, 1228, 1224, 0, 0, 1220, 1216, 1216, 1216, 1212, 1208, 0, 0
.short 1204, 1200, 1200, 1200, 1196, 1192, 0, 0, 1188, 1184, 1184, 1184, 1180, 1176, 0, 0
.short 1172, 1168, 1168, 1168, 1164, 1160, 0, 0, 1156, 1152, 1152, 1152, 1148, 1144, 0, 0
.short 1140, 1136, 1136, 1136, 1132, 1128, 0, 0, 1124, 1120, 1120, 1120, 1116, 1112, 0, 0
.short 1108, 1104, 1104, 1104, 1100, 1096, 0, 0, 1092, 1088, 1088, 1088, 1084, 1080, 0, 0
.short 1076, 1072, 1072, 1072, 1068, 1064, 0, 0, 1060, 1056, 1056, 1056, 1052, 1048, 0, 0
.short 1044, 1040, 1040, 1040, 1036, 1032, 0, 0, 1028, 1024, 1024, 1020, 1016, 1012, 0, 0
.short 760, 756, 752, 1004, 1000, 996, 0, 0, 744, 740, 736, 988, 984, 980, 0, 0
.short 728, 724, 720, 972, 968, 964, 0, 0, 712, 708, 704, 956, 952, 948, 0, 0
.short 696, 692, 688, 940, 936, 932, 0, 0, 680, 676, 672, 924, 920, 916, 0, 0
.short 664, 660, 656, 908, 904, 900, 0, 0, 648, 644, 640, 892, 888, 884, 0, 0
.short 632, 628, 624, 876, 872, 868, 0, 0, 616, 612, 608, 860, 856, 852, 0, 0
.short 600, 596, 592, 844, 840, 836, 0, 0, 584, 580, 576, 828, 824, 820, 0, 0
.short 568, 564, 560, 812, 808, 804, 0, 0, 552, 548, 544, 796, 792, 788, 0, 0
.short 536, 532, 528, 780, 776, 772, 0, 0, 520, 516, 512, 508, 504, 500, 0, 0
.short 248, 244, 240, 492, 488, 484, 0, 0, 232, 228, 224, 476, 472, 468, 0, 0
.short 216, 212, 208, 460, 456, 452, 0, 0, 200, 196, 192, 444, 440, 436, 0, 0
.short 184, 180, 176, 428, 424, 420, 0, 0, 168, 164, 160, 412, 408, 404, 0, 0
.short 152, 148, 144, 396, 392, 388, 0, 0, 136, 132, 128, 380, 376, 372, 0, 0
.short 120, 116, 112, 364, 360, 356, 0, 0, 104, 100, 96, 348, 344, 340, 0, 0
.short 88, 84, 80, 332, 328, 324, 0, 0, 72, 68, 64, 316, 312, 308, 0, 0
.short 56, 52, 48, 300, 296, 292, 0, 0, 40, 36, 32, 284, 280, 276, 0, 0
.short 24, 20, 16, 268, 264, 260, 0, 0, 8, 4, 0, 3072, 3072, 3072, 0, 0
L2c_gtab_end:
.section .rodata,"a"
.p2align 6
.amdhsa_kernel gated_mix__linear_kernel_hedgehog__ssm_conv_s4d__prompt_kernel
  .amdhsa_next_free_vgpr 304
  .amdhsa_next_free_sgpr 102
  .amdhsa_accum_offset 256
  .amdhsa_group_segment_fixed_size 0
  .amdhsa_kernarg_size 120
  .amdhsa_user_sgpr_count 2
  .amdhsa_user_sgpr_kernarg_segment_ptr 1
  .amdhsa_system_sgpr_workgroup_id_x 1
  .amdhsa_float_denorm_mode_32 3
.end_amdhsa_kernel
```
